```python
import torch

def _softmax(x, axis=-1):
    return torch.softmax(x, dim=axis)
def _gelu(x):
    return torch.nn.functional.gelu(x, approximate="tanh")
def _silu(x):
    return torch.nn.functional.silu(x)
def _sigmoid(x):
    return torch.sigmoid(x)
def _layernorm(x, axis=-1, eps=1e-5):
    m = x.mean(dim=axis, keepdim=True)
    v = x.var(dim=axis, keepdim=True, unbiased=False)
    return (x - m) / torch.sqrt(v + eps)
def _scatter_add(tgt, idx, src, axis=0):
    return tgt.clone().index_add_(axis, idx, src)
def _segment_sum(src, seg, n):
    out = torch.zeros((n,) + src.shape[1:], dtype=src.dtype)
    return out.index_add_(0, seg, src)
def _pad(x, pw):
    flat = tuple(v for pair in reversed(pw) for v in pair)
    return torch.nn.functional.pad(x, flat)

kernel_name = 'standalone__mha_softmax__near_ridge'

def setup_inputs():

    _w = (lambda a: (lambda t: t.to(torch.bfloat16) if t.is_floating_point() else t)(torch.as_tensor(a)))
    B, H, Sq, Sk, D = 8, 32, 288, 2048, 128
    return {
        "q": _w((lambda *s: torch.randn(*s, dtype=torch.bfloat16) * 0.8)(B, H, Sq, D)),
        "k": _w((lambda *s: torch.randn(*s, dtype=torch.bfloat16) * 0.8)(B, H, Sk, D)),
        "v": _w((lambda *s: torch.randn(*s, dtype=torch.bfloat16) * 0.05)(B, H, Sk, D)),
    }

def reference(q, k, v):
    scale = q.shape[-1] ** -0.5
    scores = torch.einsum("bhqd,bhkd->bhqk", q, k) * scale
    p = _softmax(scores, axis=-1)
    return torch.einsum("bhqk,bhkd->bhqd", p, v)
```

```asm
; @launch grid=(256,1,1) block=(256,1,1) lds=139264
.amdgcn_target "amdgcn-amd-amdhsa--gfx950"
.text
.globl standalone__mha_softmax__near_ridge_kernel
.p2align 8
.type standalone__mha_softmax__near_ridge_kernel,@function
standalone__mha_softmax__near_ridge_kernel:
    s_cmp_ge_u32 s2, 256
    s_cbranch_scc1 L_end
    s_load_dwordx8 s[40:47], s[0:1], 0
    s_getpc_b64 s[48:49]
L_pc:
    v_lshlrev_b32 v1, 7, v0
    v_min_u32 v1, L_codeend-L_pc-4, v1
    global_load_dword v176, v1, s[48:49]
    v_lshrrev_b32 v1, 6, v0
    v_and_b32 v2, 63, v0
    v_readfirstlane_b32 s24, v1
    v_lshrrev_b32 v6, 3, v2
    v_and_b32 v7, 7, v2
    v_lshrrev_b32 v9, 1, v6
    v_lshlrev_b32 v8, 8, v6
    v_xor_b32 v10, v9, v7
    v_lshl_add_u32 v12, v10, 4, v8
    v_xor_b32 v10, 4, v10
    v_lshl_add_u32 v13, v10, 4, v8
    v_add_u32 v13, 2048, v13
    s_lshr_b32 s34, s24, 1
    s_lshl_b32 s34, s34, 13
    s_and_b32 s38, s24, 1
    s_lshl_b32 s38, s38, 7
    s_add_u32 s34, s34, s38
    v_add_u32 v244, s34, v12
    v_add_u32 v245, s34, v13
    v_subrev_u32 v245, 1024, v245
    v_add_u32 v246, 2048, v244
    v_add_u32 v247, 2048, v245
    v_lshlrev_b32 v10, 1, v9
    v_xor_b32 v10, v10, v7
    v_lshl_add_u32 v10, v10, 4, v8
    v_add_u32 v248, s34, v10
    v_add_u32 v249, 1024, v248
    v_add_u32 v250, 2048, v248
    v_add_u32 v251, 3072, v248
    s_lshl_b32 s51, s24, 14
    s_add_u32 s50, s51, 65536
    s_lshr_b32 s34, s24, 1
    s_lshl_b32 s34, s34, 12
    s_add_u32 s34, s34, 65536
    s_add_u32 s52, s34, 65536
    s_and_b32 s37, s24, 1
    s_lshl_b32 s38, s37, 7
    s_add_u32 s53, s34, s38
    s_lshl_b32 s37, s37, 11
    s_add_u32 s54, s52, s37
    s_lshr_b32 s29, s24, 1
    s_lshl_b32 s29, s29, 13
    s_add_u32 s29, s29, s38
    s_mul_i32 s34, s2, 73728
    s_lshl_b32 s38, s2, 19
    s_mov_b32 s18, 73728
    s_mov_b32 s19, 0x20000
    s_mov_b32 s11, 0x20000
    s_mov_b32 s15, 0x20000
    s_mov_b32 s22, 73728
    s_mov_b32 s23, 0x20000
    s_mov_b32 s36, 0
    s_lshl_b32 s27, s24, 12
    s_mov_b32 s39, 0
    s_waitcnt lgkmcnt(0)
    s_add_u32 s8, s42, s38
    s_addc_u32 s9, s43, 0
    s_add_u32 s16, s40, s34
    s_addc_u32 s17, s41, 0
    s_add_u32 s12, s44, s38
    s_addc_u32 s13, s45, 0
    s_add_u32 s20, s46, s34
    s_addc_u32 s21, s47, 0
L_restart:
    v_subrev_u32 v252, s29, v244
    v_subrev_u32 v253, s29, v245
    v_add_u32 v253, 1024, v253
    s_mov_b32 s10, 0x80000
    s_mov_b32 s14, 0x80000
    s_mov_b32 s26, s39
    s_mov_b32 s28, 31
    s_mov_b32 m0, s27
    s_nop 0
    buffer_load_dwordx4 v244, s[8:11], s26 offen offset:0 nt lds
    buffer_load_dwordx4 v245, s[8:11], s26 offen offset:1024 nt lds
    buffer_load_dwordx4 v246, s[8:11], s26 offen offset:2048 nt lds
    buffer_load_dwordx4 v247, s[8:11], s26 offen offset:3072 nt lds
    s_mov_b32 m0, s54
    s_nop 0
    buffer_load_dwordx4 v252, s[16:19], s53 offen nt lds
    s_add_u32 m0, s54, 1024
    s_nop 0
    buffer_load_dwordx4 v253, s[16:19], s53 offen nt lds
    s_add_u32 s38, s51, 0
    s_add_u32 m0, s50, 0
    s_nop 0
    buffer_load_dwordx4 v252, s[16:19], s38 offen nt lds
    s_add_u32 m0, s50, 1024
    s_nop 0
    buffer_load_dwordx4 v253, s[16:19], s38 offen nt lds
    s_add_u32 s38, s51, 128
    s_add_u32 m0, s50, 2048
    s_nop 0
    buffer_load_dwordx4 v252, s[16:19], s38 offen nt lds
    s_add_u32 m0, s50, 3072
    s_nop 0
    buffer_load_dwordx4 v253, s[16:19], s38 offen nt lds
    s_cmp_lg_u32 s36, 0
    s_cbranch_scc1 L_skipset
    v_and_b32 v3, 15, v2
    v_lshrrev_b32 v4, 4, v2
    v_lshlrev_b32 v8, 7, v3
    v_lshrrev_b32 v9, 1, v3
    v_xor_b32 v9, v9, v4
    v_lshl_add_u32 v226, v9, 4, v8
    v_xor_b32 v10, 4, v9
    v_lshl_add_u32 v227, v10, 4, v8
    s_and_b32 s34, s24, 1
    s_lshl_b32 s34, s34, 13
    s_xor_b32 s38, s34, 8192
    v_add_u32 v232, s38, v226
    v_add_u32 v234, s34, v226
    v_add_u32 v254, s50, v226
    v_add_u32 v224, s52, v226
    v_add_u32 v233, s38, v227
    v_add_u32 v235, s34, v227
    v_add_u32 v255, s50, v227
    v_add_u32 v225, s52, v227
    v_lshrrev_b32 v8, 2, v2
    v_lshlrev_b32 v9, 7, v8
    v_and_b32 v10, 3, v2
    v_lshl_add_u32 v9, v10, 3, v9
    v_bfe_u32 v8, v8, 1, 2
    v_xor_b32 v11, 0, v8
    v_lshl_add_u32 v11, v11, 5, v9
    v_add_u32 v236, s38, v11
    v_add_u32 v240, s34, v11
    v_xor_b32 v11, 1, v8
    v_lshl_add_u32 v11, v11, 5, v9
    v_add_u32 v237, s38, v11
    v_add_u32 v241, s34, v11
    v_xor_b32 v11, 2, v8
    v_lshl_add_u32 v11, v11, 5, v9
    v_add_u32 v238, s38, v11
    v_add_u32 v242, s34, v11
    v_xor_b32 v11, 3, v8
    v_lshl_add_u32 v11, v11, 5, v9
    v_add_u32 v239, s38, v11
    v_add_u32 v243, s34, v11
    v_lshlrev_b32 v5, 8, v3
    v_and_b32 v8, 1, v4
    v_lshl_add_u32 v5, v8, 5, v5
    v_lshrrev_b32 v8, 1, v4
    v_lshl_add_u32 v5, v8, 4, v5
    v_cmp_eq_u32 vcc, 0, v10
    v_mov_b32 v8, 0
    v_mov_b32 v9, 0x3f803f80
    v_cndmask_b32 v8, v8, v9, vcc
    v_accvgpr_write_b32 a232, 0
    v_accvgpr_write_b32 a233, 0
    v_accvgpr_write_b32 a234, 0
    v_accvgpr_write_b32 a235, 0
    v_accvgpr_write_b32 a228, v8
    v_accvgpr_write_b32 a229, v8
    v_accvgpr_write_b32 a230, v8
    v_accvgpr_write_b32 a231, v8
    s_mov_b32 s55, 0x3e0293ee
    s_mov_b32 s25, 0xffff0000
L_skipset:
    v_mfma_f32_32x32x16_bf16 a[208:223], a[232:235], a[232:235], 0
    v_mfma_f32_16x16x32_bf16 a[224:227], a[232:235], a[232:235], 0
    v_mfma_f32_32x32x16_bf16 v[16:31], a[232:235], a[232:235], 0
    v_mfma_f32_32x32x16_bf16 v[32:47], a[232:235], a[232:235], 0
    v_mfma_f32_32x32x16_bf16 v[48:63], a[232:235], a[232:235], 0
    v_mfma_f32_32x32x16_bf16 v[64:79], a[232:235], a[232:235], 0
    v_mfma_f32_32x32x16_bf16 v[80:95], a[232:235], a[232:235], 0
    v_mfma_f32_32x32x16_bf16 v[96:111], a[232:235], a[232:235], 0
    v_mfma_f32_32x32x16_bf16 v[112:127], a[232:235], a[232:235], 0
    v_mfma_f32_32x32x16_bf16 v[128:143], a[232:235], a[232:235], 0
    v_mfma_f32_32x32x16_bf16 v[144:159], a[232:235], a[232:235], 0
    v_mfma_f32_32x32x16_bf16 v[160:175], a[232:235], a[232:235], 0
    s_add_u32 s38, s51, 4096
    s_add_u32 m0, s50, 4096
    s_nop 0
    buffer_load_dwordx4 v252, s[16:19], s38 offen nt lds
    s_add_u32 m0, s50, 5120
    s_nop 0
    buffer_load_dwordx4 v253, s[16:19], s38 offen nt lds
    s_add_u32 s38, s51, 4224
    s_add_u32 m0, s50, 6144
    s_nop 0
    buffer_load_dwordx4 v252, s[16:19], s38 offen nt lds
    s_add_u32 m0, s50, 7168
    s_nop 0
    buffer_load_dwordx4 v253, s[16:19], s38 offen nt lds
    s_waitcnt vmcnt(8)
    s_barrier
    ds_read_b128 a[80:83], v232 offset:0
    ds_read_b128 a[84:87], v233 offset:0
    ds_read_b128 a[88:91], v232 offset:4096
    ds_read_b128 a[92:95], v233 offset:4096
    ds_read_b128 a[96:99], v232 offset:2048
    ds_read_b128 a[100:103], v233 offset:2048
    ds_read_b128 a[104:107], v232 offset:6144
    ds_read_b128 a[108:111], v233 offset:6144
    ds_read_b128 a[112:115], v234 offset:0
    ds_read_b128 a[116:119], v235 offset:0
    ds_read_b128 a[120:123], v234 offset:4096
    ds_read_b128 a[124:127], v235 offset:4096
    ds_read_b128 a[128:131], v234 offset:2048
    ds_read_b128 a[132:135], v235 offset:2048
    ds_read_b128 a[136:139], v234 offset:6144
    ds_read_b128 a[140:143], v235 offset:6144
    s_add_u32 m0, s27, 16384
    s_nop 0
    buffer_load_dwordx4 v248, s[12:15], s26 offen offset:0 nt lds
    buffer_load_dwordx4 v249, s[12:15], s26 offen offset:1024 nt lds
    buffer_load_dwordx4 v250, s[12:15], s26 offen offset:2048 nt lds
    buffer_load_dwordx4 v251, s[12:15], s26 offen offset:3072 nt lds
    s_add_u32 s26, s26, 16384
    s_and_b32 s26, s26, 0x7ffff
    s_sub_u32 s28, s28, 1
    s_cselect_b32 s10, 0, s10
    s_cselect_b32 s14, 0, s14
    s_cmp_lg_u32 s36, 0
    s_cbranch_scc1 L_sq1
    ds_read_b128 v[196:199], v224 offset:0
    ds_read_b128 v[200:203], v225 offset:0
    ds_read_b128 v[204:207], v224 offset:2048
    ds_read_b128 v[208:211], v225 offset:2048
    ds_read_b128 a[176:179], v226 offset:0
    ds_read_b128 a[180:183], v227 offset:0
    ds_read_b128 a[184:187], v226 offset:4096
    ds_read_b128 a[188:191], v227 offset:4096
    s_waitcnt lgkmcnt(4)
    v_lshlrev_b32 v6, 16, v196
    v_and_b32 v7, s25, v196
    v_mul_f32 v6, s55, v6
    v_mul_f32 v7, s55, v7
    v_cvt_pk_bf16_f32 v196, v6, v7
    v_lshlrev_b32 v8, 16, v197
    v_and_b32 v9, s25, v197
    v_mul_f32 v8, s55, v8
    v_mul_f32 v9, s55, v9
    v_cvt_pk_bf16_f32 v197, v8, v9
    v_accvgpr_write_b32 a64, v196
    v_lshlrev_b32 v10, 16, v198
    v_and_b32 v11, s25, v198
    v_mul_f32 v10, s55, v10
    v_mul_f32 v11, s55, v11
    v_cvt_pk_bf16_f32 v198, v10, v11
    v_accvgpr_write_b32 a65, v197
    v_lshlrev_b32 v12, 16, v199
    v_and_b32 v13, s25, v199
    v_mul_f32 v12, s55, v12
    v_mul_f32 v13, s55, v13
    v_cvt_pk_bf16_f32 v199, v12, v13
    v_accvgpr_write_b32 a66, v198
    v_lshlrev_b32 v6, 16, v200
    v_and_b32 v7, s25, v200
    v_mul_f32 v6, s55, v6
    v_mul_f32 v7, s55, v7
    v_cvt_pk_bf16_f32 v200, v6, v7
    v_accvgpr_write_b32 a67, v199
    v_lshlrev_b32 v8, 16, v201
    v_and_b32 v9, s25, v201
    v_mul_f32 v8, s55, v8
    v_mul_f32 v9, s55, v9
    v_cvt_pk_bf16_f32 v201, v8, v9
    v_accvgpr_write_b32 a68, v200
    v_lshlrev_b32 v10, 16, v202
    v_and_b32 v11, s25, v202
    v_mul_f32 v10, s55, v10
    v_mul_f32 v11, s55, v11
    v_cvt_pk_bf16_f32 v202, v10, v11
    v_accvgpr_write_b32 a69, v201
    v_lshlrev_b32 v12, 16, v203
    v_and_b32 v13, s25, v203
    v_mul_f32 v12, s55, v12
    v_mul_f32 v13, s55, v13
    v_cvt_pk_bf16_f32 v203, v12, v13
    v_accvgpr_write_b32 a70, v202
    v_lshlrev_b32 v6, 16, v204
    v_and_b32 v7, s25, v204
    v_mul_f32 v6, s55, v6
    v_mul_f32 v7, s55, v7
    v_cvt_pk_bf16_f32 v204, v6, v7
    v_accvgpr_write_b32 a71, v203
    v_lshlrev_b32 v8, 16, v205
    v_and_b32 v9, s25, v205
    v_mul_f32 v8, s55, v8
    v_mul_f32 v9, s55, v9
    v_cvt_pk_bf16_f32 v205, v8, v9
    v_accvgpr_write_b32 a72, v204
    v_lshlrev_b32 v10, 16, v206
    v_and_b32 v11, s25, v206
    v_mul_f32 v10, s55, v10
    v_mul_f32 v11, s55, v11
    v_cvt_pk_bf16_f32 v206, v10, v11
    v_accvgpr_write_b32 a73, v205
    v_lshlrev_b32 v12, 16, v207
    v_and_b32 v13, s25, v207
    v_mul_f32 v12, s55, v12
    v_mul_f32 v13, s55, v13
    v_cvt_pk_bf16_f32 v207, v12, v13
    v_accvgpr_write_b32 a74, v206
    v_lshlrev_b32 v6, 16, v208
    v_and_b32 v7, s25, v208
    v_mul_f32 v6, s55, v6
    v_mul_f32 v7, s55, v7
    v_cvt_pk_bf16_f32 v208, v6, v7
    v_accvgpr_write_b32 a75, v207
    v_lshlrev_b32 v8, 16, v209
    v_and_b32 v9, s25, v209
    v_mul_f32 v8, s55, v8
    v_mul_f32 v9, s55, v9
    v_cvt_pk_bf16_f32 v209, v8, v9
    v_accvgpr_write_b32 a76, v208
    v_lshlrev_b32 v10, 16, v210
    v_and_b32 v11, s25, v210
    v_mul_f32 v10, s55, v10
    v_mul_f32 v11, s55, v11
    v_cvt_pk_bf16_f32 v210, v10, v11
    v_accvgpr_write_b32 a77, v209
    v_lshlrev_b32 v12, 16, v211
    v_and_b32 v13, s25, v211
    v_mul_f32 v12, s55, v12
    v_mul_f32 v13, s55, v13
    v_cvt_pk_bf16_f32 v211, v12, v13
    v_accvgpr_write_b32 a78, v210
    v_accvgpr_write_b32 a79, v211
    s_waitcnt lgkmcnt(0)
    s_nop 0
    v_mfma_f32_16x16x32_bf16 v[176:179], a[176:179], a[64:67], 0
    v_mfma_f32_16x16x32_bf16 v[176:179], a[180:183], a[68:71], v[176:179]
    v_mfma_f32_16x16x32_bf16 v[176:179], a[184:187], a[72:75], v[176:179]
    v_mfma_f32_16x16x32_bf16 v[176:179], a[188:191], a[76:79], v[176:179]
    s_nop 7
    v_max3_f32 v10, v176, v177, v178
    v_max_f32 v10, v10, v179
    v_mov_b32 v15, v10
    s_nop 1
    v_permlane16_swap_b32 v10, v15
    s_nop 0
    v_max_f32 v10, v10, v15
    v_mov_b32 v15, v10
    s_nop 1
    v_permlane32_swap_b32 v10, v15
    s_nop 0
    v_max_f32 v10, v10, v15
    v_sub_f32 v228, 0, v10
    v_sub_f32 v229, 0, v10
    v_sub_f32 v230, 0, v10
    v_sub_f32 v231, 0, v10
L_sq1:
    s_waitcnt vmcnt(8)
    s_add_u32 s38, s51, 8192
    s_add_u32 m0, s50, 8192
    s_nop 0
    buffer_load_dwordx4 v252, s[16:19], s38 offen nt lds
    s_add_u32 m0, s50, 9216
    s_nop 0
    buffer_load_dwordx4 v253, s[16:19], s38 offen nt lds
    s_add_u32 s38, s51, 8320
    s_add_u32 m0, s50, 10240
    s_nop 0
    buffer_load_dwordx4 v252, s[16:19], s38 offen nt lds
    s_add_u32 m0, s50, 11264
    s_nop 0
    buffer_load_dwordx4 v253, s[16:19], s38 offen nt lds
    s_cmp_lg_u32 s36, 0
    s_cbranch_scc1 L_sq2
    ds_read_b128 v[196:199], v254 offset:0
    ds_read_b128 v[200:203], v255 offset:0
    ds_read_b128 v[204:207], v254 offset:2048
    ds_read_b128 v[208:211], v255 offset:2048
    s_waitcnt lgkmcnt(0)
    v_lshlrev_b32 v6, 16, v196
    v_and_b32 v7, s25, v196
    v_mul_f32 v6, s55, v6
    v_mul_f32 v7, s55, v7
    v_cvt_pk_bf16_f32 v196, v6, v7
    v_lshlrev_b32 v8, 16, v197
    v_and_b32 v9, s25, v197
    v_mul_f32 v8, s55, v8
    v_mul_f32 v9, s55, v9
    v_cvt_pk_bf16_f32 v197, v8, v9
    v_accvgpr_write_b32 a0, v196
    v_lshlrev_b32 v10, 16, v198
    v_and_b32 v11, s25, v198
    v_mul_f32 v10, s55, v10
    v_mul_f32 v11, s55, v11
    v_cvt_pk_bf16_f32 v198, v10, v11
    v_accvgpr_write_b32 a1, v197
    v_lshlrev_b32 v12, 16, v199
    v_and_b32 v13, s25, v199
    v_mul_f32 v12, s55, v12
    v_mul_f32 v13, s55, v13
    v_cvt_pk_bf16_f32 v199, v12, v13
    v_accvgpr_write_b32 a2, v198
    v_lshlrev_b32 v6, 16, v200
    v_and_b32 v7, s25, v200
    v_mul_f32 v6, s55, v6
    v_mul_f32 v7, s55, v7
    v_cvt_pk_bf16_f32 v200, v6, v7
    v_accvgpr_write_b32 a3, v199
    v_lshlrev_b32 v8, 16, v201
    v_and_b32 v9, s25, v201
    v_mul_f32 v8, s55, v8
    v_mul_f32 v9, s55, v9
    v_cvt_pk_bf16_f32 v201, v8, v9
    v_accvgpr_write_b32 a4, v200
    v_lshlrev_b32 v10, 16, v202
    v_and_b32 v11, s25, v202
    v_mul_f32 v10, s55, v10
    v_mul_f32 v11, s55, v11
    v_cvt_pk_bf16_f32 v202, v10, v11
    v_accvgpr_write_b32 a5, v201
    v_lshlrev_b32 v12, 16, v203
    v_and_b32 v13, s25, v203
    v_mul_f32 v12, s55, v12
    v_mul_f32 v13, s55, v13
    v_cvt_pk_bf16_f32 v203, v12, v13
    v_accvgpr_write_b32 a6, v202
    v_lshlrev_b32 v6, 16, v204
    v_and_b32 v7, s25, v204
    v_mul_f32 v6, s55, v6
    v_mul_f32 v7, s55, v7
    v_cvt_pk_bf16_f32 v204, v6, v7
    v_accvgpr_write_b32 a7, v203
    v_lshlrev_b32 v8, 16, v205
    v_and_b32 v9, s25, v205
    v_mul_f32 v8, s55, v8
    v_mul_f32 v9, s55, v9
    v_cvt_pk_bf16_f32 v205, v8, v9
    v_accvgpr_write_b32 a8, v204
    v_lshlrev_b32 v10, 16, v206
    v_and_b32 v11, s25, v206
    v_mul_f32 v10, s55, v10
    v_mul_f32 v11, s55, v11
    v_cvt_pk_bf16_f32 v206, v10, v11
    v_accvgpr_write_b32 a9, v205
    v_lshlrev_b32 v12, 16, v207
    v_and_b32 v13, s25, v207
    v_mul_f32 v12, s55, v12
    v_mul_f32 v13, s55, v13
    v_cvt_pk_bf16_f32 v207, v12, v13
    v_accvgpr_write_b32 a10, v206
    v_lshlrev_b32 v6, 16, v208
    v_and_b32 v7, s25, v208
    v_mul_f32 v6, s55, v6
    v_mul_f32 v7, s55, v7
    v_cvt_pk_bf16_f32 v208, v6, v7
    v_accvgpr_write_b32 a11, v207
    v_lshlrev_b32 v8, 16, v209
    v_and_b32 v9, s25, v209
    v_mul_f32 v8, s55, v8
    v_mul_f32 v9, s55, v9
    v_cvt_pk_bf16_f32 v209, v8, v9
    v_accvgpr_write_b32 a12, v208
    v_lshlrev_b32 v10, 16, v210
    v_and_b32 v11, s25, v210
    v_mul_f32 v10, s55, v10
    v_mul_f32 v11, s55, v11
    v_cvt_pk_bf16_f32 v210, v10, v11
    v_accvgpr_write_b32 a13, v209
    v_lshlrev_b32 v12, 16, v211
    v_and_b32 v13, s25, v211
    v_mul_f32 v12, s55, v12
    v_mul_f32 v13, s55, v13
    v_cvt_pk_bf16_f32 v211, v12, v13
    v_accvgpr_write_b32 a14, v210
    v_accvgpr_write_b32 a15, v211
    s_waitcnt lgkmcnt(0)
    s_nop 0
    v_mfma_f32_16x16x32_bf16 v[176:179], a[80:83], a[0:3], 0
    v_mfma_f32_16x16x32_bf16 v[176:179], a[84:87], a[4:7], v[176:179]
    v_mfma_f32_16x16x32_bf16 v[176:179], a[88:91], a[8:11], v[176:179]
    v_mfma_f32_16x16x32_bf16 v[176:179], a[92:95], a[12:15], v[176:179]
    s_nop 7
    v_max3_f32 v6, v176, v177, v178
    v_max_f32 v6, v6, v179
    v_mov_b32 v11, v6
    s_nop 1
    v_permlane16_swap_b32 v6, v11
    s_nop 0
    v_max_f32 v6, v6, v11
    v_mov_b32 v11, v6
    s_nop 1
    v_permlane32_swap_b32 v6, v11
    s_nop 0
    v_max_f32 v6, v6, v11
    v_sub_f32 v212, 0, v6
    v_sub_f32 v213, 0, v6
    v_sub_f32 v214, 0, v6
    v_sub_f32 v215, 0, v6
L_sq2:
    s_waitcnt vmcnt(8)
    s_add_u32 s38, s51, 12288
    s_add_u32 m0, s50, 12288
    s_nop 0
    buffer_load_dwordx4 v252, s[16:19], s38 offen nt lds
    s_add_u32 m0, s50, 13312
    s_nop 0
    buffer_load_dwordx4 v253, s[16:19], s38 offen nt lds
    s_add_u32 s38, s51, 12416
    s_add_u32 m0, s50, 14336
    s_nop 0
    buffer_load_dwordx4 v252, s[16:19], s38 offen nt lds
    s_add_u32 m0, s50, 15360
    s_nop 0
    buffer_load_dwordx4 v253, s[16:19], s38 offen nt lds
    s_cmp_lg_u32 s36, 0
    s_cbranch_scc1 L_sq3
    ds_read_b128 v[196:199], v254 offset:4096
    ds_read_b128 v[200:203], v255 offset:4096
    ds_read_b128 v[204:207], v254 offset:6144
    ds_read_b128 v[208:211], v255 offset:6144
    s_waitcnt lgkmcnt(0)
    v_lshlrev_b32 v6, 16, v196
    v_and_b32 v7, s25, v196
    v_mul_f32 v6, s55, v6
    v_mul_f32 v7, s55, v7
    v_cvt_pk_bf16_f32 v196, v6, v7
    v_lshlrev_b32 v8, 16, v197
    v_and_b32 v9, s25, v197
    v_mul_f32 v8, s55, v8
    v_mul_f32 v9, s55, v9
    v_cvt_pk_bf16_f32 v197, v8, v9
    v_accvgpr_write_b32 a16, v196
    v_lshlrev_b32 v10, 16, v198
    v_and_b32 v11, s25, v198
    v_mul_f32 v10, s55, v10
    v_mul_f32 v11, s55, v11
    v_cvt_pk_bf16_f32 v198, v10, v11
    v_accvgpr_write_b32 a17, v197
    v_lshlrev_b32 v12, 16, v199
    v_and_b32 v13, s25, v199
    v_mul_f32 v12, s55, v12
    v_mul_f32 v13, s55, v13
    v_cvt_pk_bf16_f32 v199, v12, v13
    v_accvgpr_write_b32 a18, v198
    v_lshlrev_b32 v6, 16, v200
    v_and_b32 v7, s25, v200
    v_mul_f32 v6, s55, v6
    v_mul_f32 v7, s55, v7
    v_cvt_pk_bf16_f32 v200, v6, v7
    v_accvgpr_write_b32 a19, v199
    v_lshlrev_b32 v8, 16, v201
    v_and_b32 v9, s25, v201
    v_mul_f32 v8, s55, v8
    v_mul_f32 v9, s55, v9
    v_cvt_pk_bf16_f32 v201, v8, v9
    v_accvgpr_write_b32 a20, v200
    v_lshlrev_b32 v10, 16, v202
    v_and_b32 v11, s25, v202
    v_mul_f32 v10, s55, v10
    v_mul_f32 v11, s55, v11
    v_cvt_pk_bf16_f32 v202, v10, v11
    v_accvgpr_write_b32 a21, v201
    v_lshlrev_b32 v12, 16, v203
    v_and_b32 v13, s25, v203
    v_mul_f32 v12, s55, v12
    v_mul_f32 v13, s55, v13
    v_cvt_pk_bf16_f32 v203, v12, v13
    v_accvgpr_write_b32 a22, v202
    v_lshlrev_b32 v6, 16, v204
    v_and_b32 v7, s25, v204
    v_mul_f32 v6, s55, v6
    v_mul_f32 v7, s55, v7
    v_cvt_pk_bf16_f32 v204, v6, v7
    v_accvgpr_write_b32 a23, v203
    v_lshlrev_b32 v8, 16, v205
    v_and_b32 v9, s25, v205
    v_mul_f32 v8, s55, v8
    v_mul_f32 v9, s55, v9
    v_cvt_pk_bf16_f32 v205, v8, v9
    v_accvgpr_write_b32 a24, v204
    v_lshlrev_b32 v10, 16, v206
    v_and_b32 v11, s25, v206
    v_mul_f32 v10, s55, v10
    v_mul_f32 v11, s55, v11
    v_cvt_pk_bf16_f32 v206, v10, v11
    v_accvgpr_write_b32 a25, v205
    v_lshlrev_b32 v12, 16, v207
    v_and_b32 v13, s25, v207
    v_mul_f32 v12, s55, v12
    v_mul_f32 v13, s55, v13
    v_cvt_pk_bf16_f32 v207, v12, v13
    v_accvgpr_write_b32 a26, v206
    v_lshlrev_b32 v6, 16, v208
    v_and_b32 v7, s25, v208
    v_mul_f32 v6, s55, v6
    v_mul_f32 v7, s55, v7
    v_cvt_pk_bf16_f32 v208, v6, v7
    v_accvgpr_write_b32 a27, v207
    v_lshlrev_b32 v8, 16, v209
    v_and_b32 v9, s25, v209
    v_mul_f32 v8, s55, v8
    v_mul_f32 v9, s55, v9
    v_cvt_pk_bf16_f32 v209, v8, v9
    v_accvgpr_write_b32 a28, v208
    v_lshlrev_b32 v10, 16, v210
    v_and_b32 v11, s25, v210
    v_mul_f32 v10, s55, v10
    v_mul_f32 v11, s55, v11
    v_cvt_pk_bf16_f32 v210, v10, v11
    v_accvgpr_write_b32 a29, v209
    v_lshlrev_b32 v12, 16, v211
    v_and_b32 v13, s25, v211
    v_mul_f32 v12, s55, v12
    v_mul_f32 v13, s55, v13
    v_cvt_pk_bf16_f32 v211, v12, v13
    v_accvgpr_write_b32 a30, v210
    v_accvgpr_write_b32 a31, v211
    s_waitcnt lgkmcnt(0)
    s_nop 0
    v_mfma_f32_16x16x32_bf16 v[176:179], a[80:83], a[16:19], 0
    v_mfma_f32_16x16x32_bf16 v[176:179], a[84:87], a[20:23], v[176:179]
    v_mfma_f32_16x16x32_bf16 v[176:179], a[88:91], a[24:27], v[176:179]
    v_mfma_f32_16x16x32_bf16 v[176:179], a[92:95], a[28:31], v[176:179]
    s_nop 7
    v_max3_f32 v7, v176, v177, v178
    v_max_f32 v7, v7, v179
    v_mov_b32 v12, v7
    s_nop 1
    v_permlane16_swap_b32 v7, v12
    s_nop 0
    v_max_f32 v7, v7, v12
    v_mov_b32 v12, v7
    s_nop 1
    v_permlane32_swap_b32 v7, v12
    s_nop 0
    v_max_f32 v7, v7, v12
    v_sub_f32 v216, 0, v7
    v_sub_f32 v217, 0, v7
    v_sub_f32 v218, 0, v7
    v_sub_f32 v219, 0, v7
L_sq3:
    s_waitcnt lgkmcnt(0)
    s_nop 1
    v_mfma_f32_16x16x32_bf16 v[176:179], a[80:83], a[0:3], v[212:215]
    v_mfma_f32_16x16x32_bf16 v[176:179], a[84:87], a[4:7], v[176:179]
    v_mfma_f32_16x16x32_bf16 v[176:179], a[88:91], a[8:11], v[176:179]
    v_mfma_f32_16x16x32_bf16 v[176:179], a[92:95], a[12:15], v[176:179]
    v_mfma_f32_16x16x32_bf16 v[180:183], a[96:99], a[0:3], v[212:215]
    v_mfma_f32_16x16x32_bf16 v[180:183], a[100:103], a[4:7], v[180:183]
    v_mfma_f32_16x16x32_bf16 v[180:183], a[104:107], a[8:11], v[180:183]
    v_mfma_f32_16x16x32_bf16 v[180:183], a[108:111], a[12:15], v[180:183]
    v_mfma_f32_16x16x32_bf16 v[184:187], a[80:83], a[16:19], v[216:219]
    v_mfma_f32_16x16x32_bf16 v[184:187], a[84:87], a[20:23], v[184:187]
    v_mfma_f32_16x16x32_bf16 v[184:187], a[88:91], a[24:27], v[184:187]
    v_mfma_f32_16x16x32_bf16 v[184:187], a[92:95], a[28:31], v[184:187]
    v_mfma_f32_16x16x32_bf16 v[188:191], a[96:99], a[16:19], v[216:219]
    v_mfma_f32_16x16x32_bf16 v[188:191], a[100:103], a[20:23], v[188:191]
    v_mfma_f32_16x16x32_bf16 v[188:191], a[104:107], a[24:27], v[188:191]
    v_mfma_f32_16x16x32_bf16 v[188:191], a[108:111], a[28:31], v[188:191]
    v_exp_f32 v176, v176
    v_exp_f32 v177, v177
    v_exp_f32 v178, v178
    v_exp_f32 v179, v179
    v_exp_f32 v180, v180
    v_exp_f32 v181, v181
    v_exp_f32 v182, v182
    v_exp_f32 v183, v183
    v_exp_f32 v184, v184
    v_exp_f32 v185, v185
    v_exp_f32 v186, v186
    v_exp_f32 v187, v187
    v_exp_f32 v188, v188
    v_exp_f32 v189, v189
    v_exp_f32 v190, v190
    v_exp_f32 v191, v191
    v_cvt_pk_bf16_f32 v200, v176, v177
    v_cvt_pk_bf16_f32 v201, v178, v179
    v_cvt_pk_bf16_f32 v202, v180, v181
    v_cvt_pk_bf16_f32 v203, v182, v183
    v_cvt_pk_bf16_f32 v204, v184, v185
    v_cvt_pk_bf16_f32 v205, v186, v187
    v_cvt_pk_bf16_f32 v206, v188, v189
    v_cvt_pk_bf16_f32 v207, v190, v191
    s_nop 1
    s_waitcnt vmcnt(8)
    s_barrier
    ds_read_b64_tr_b16 a[144:145], v236 offset:16384
    ds_read_b64_tr_b16 a[146:147], v236 offset:18432
    ds_read_b64_tr_b16 a[148:149], v237 offset:16384
    ds_read_b64_tr_b16 a[150:151], v237 offset:18432
    ds_read_b64_tr_b16 a[152:153], v238 offset:16384
    ds_read_b64_tr_b16 a[154:155], v238 offset:18432
    ds_read_b64_tr_b16 a[156:157], v239 offset:16384
    ds_read_b64_tr_b16 a[158:159], v239 offset:18432
    ds_read_b64_tr_b16 a[160:161], v236 offset:20480
    ds_read_b64_tr_b16 a[162:163], v236 offset:22528
    ds_read_b64_tr_b16 a[164:165], v237 offset:20480
    ds_read_b64_tr_b16 a[166:167], v237 offset:22528
    ds_read_b64_tr_b16 a[168:169], v238 offset:20480
    ds_read_b64_tr_b16 a[170:171], v238 offset:22528
    ds_read_b64_tr_b16 a[172:173], v239 offset:20480
    ds_read_b64_tr_b16 a[174:175], v239 offset:22528
    ds_read_b64_tr_b16 a[176:177], v240 offset:16384
    ds_read_b64_tr_b16 a[178:179], v240 offset:18432
    ds_read_b64_tr_b16 a[180:181], v241 offset:16384
    ds_read_b64_tr_b16 a[182:183], v241 offset:18432
    ds_read_b64_tr_b16 a[184:185], v242 offset:16384
    ds_read_b64_tr_b16 a[186:187], v242 offset:18432
    ds_read_b64_tr_b16 a[188:189], v243 offset:16384
    ds_read_b64_tr_b16 a[190:191], v243 offset:18432
    ds_read_b64_tr_b16 a[192:193], v240 offset:20480
    ds_read_b64_tr_b16 a[194:195], v240 offset:22528
    ds_read_b64_tr_b16 a[196:197], v241 offset:20480
    ds_read_b64_tr_b16 a[198:199], v241 offset:22528
    ds_read_b64_tr_b16 a[200:201], v242 offset:20480
    ds_read_b64_tr_b16 a[202:203], v242 offset:22528
    ds_read_b64_tr_b16 a[204:205], v243 offset:20480
    ds_read_b64_tr_b16 a[206:207], v243 offset:22528
    s_add_u32 m0, s27, 32768
    s_nop 0
    buffer_load_dwordx4 v244, s[8:11], s26 offen offset:0 nt lds
    buffer_load_dwordx4 v245, s[8:11], s26 offen offset:1024 nt lds
    buffer_load_dwordx4 v246, s[8:11], s26 offen offset:2048 nt lds
    buffer_load_dwordx4 v247, s[8:11], s26 offen offset:3072 nt lds
    s_waitcnt lgkmcnt(15)
    v_mfma_f32_16x16x32_bf16 v[16:19], a[144:147], v[200:203], v[16:19]
    v_mfma_f32_16x16x32_bf16 v[20:23], a[148:151], v[200:203], v[20:23]
    v_mfma_f32_16x16x32_bf16 v[24:27], a[152:155], v[200:203], v[24:27]
    v_mfma_f32_16x16x32_bf16 v[28:31], a[156:159], v[200:203], v[28:31]
    v_mfma_f32_16x16x32_bf16 v[32:35], a[160:163], v[200:203], v[32:35]
    v_mfma_f32_16x16x32_bf16 v[36:39], a[164:167], v[200:203], v[36:39]
    v_mfma_f32_16x16x32_bf16 v[40:43], a[168:171], v[200:203], v[40:43]
    v_mfma_f32_16x16x32_bf16 v[44:47], a[172:175], v[200:203], v[44:47]
    v_mfma_f32_16x16x32_bf16 a[208:211], a[228:231], v[200:203], a[208:211]
    v_mfma_f32_16x16x32_bf16 v[48:51], a[144:147], v[204:207], v[48:51]
    v_mfma_f32_16x16x32_bf16 v[52:55], a[148:151], v[204:207], v[52:55]
    v_mfma_f32_16x16x32_bf16 v[56:59], a[152:155], v[204:207], v[56:59]
    v_mfma_f32_16x16x32_bf16 v[60:63], a[156:159], v[204:207], v[60:63]
    v_mfma_f32_16x16x32_bf16 v[64:67], a[160:163], v[204:207], v[64:67]
    v_mfma_f32_16x16x32_bf16 v[68:71], a[164:167], v[204:207], v[68:71]
    v_mfma_f32_16x16x32_bf16 v[72:75], a[168:171], v[204:207], v[72:75]
    v_mfma_f32_16x16x32_bf16 v[76:79], a[172:175], v[204:207], v[76:79]
    v_mfma_f32_16x16x32_bf16 a[212:215], a[228:231], v[204:207], a[212:215]
    s_nop 1
    v_mfma_f32_16x16x32_bf16 v[176:179], a[112:115], a[0:3], v[212:215]
    v_mfma_f32_16x16x32_bf16 v[176:179], a[116:119], a[4:7], v[176:179]
    v_mfma_f32_16x16x32_bf16 v[176:179], a[120:123], a[8:11], v[176:179]
    v_mfma_f32_16x16x32_bf16 v[176:179], a[124:127], a[12:15], v[176:179]
    v_mfma_f32_16x16x32_bf16 v[180:183], a[128:131], a[0:3], v[212:215]
    v_mfma_f32_16x16x32_bf16 v[180:183], a[132:135], a[4:7], v[180:183]
    v_mfma_f32_16x16x32_bf16 v[180:183], a[136:139], a[8:11], v[180:183]
    v_mfma_f32_16x16x32_bf16 v[180:183], a[140:143], a[12:15], v[180:183]
    v_mfma_f32_16x16x32_bf16 v[184:187], a[112:115], a[16:19], v[216:219]
    v_mfma_f32_16x16x32_bf16 v[184:187], a[116:119], a[20:23], v[184:187]
    v_mfma_f32_16x16x32_bf16 v[184:187], a[120:123], a[24:27], v[184:187]
    v_mfma_f32_16x16x32_bf16 v[184:187], a[124:127], a[28:31], v[184:187]
    v_mfma_f32_16x16x32_bf16 v[188:191], a[128:131], a[16:19], v[216:219]
    v_mfma_f32_16x16x32_bf16 v[188:191], a[132:135], a[20:23], v[188:191]
    v_mfma_f32_16x16x32_bf16 v[188:191], a[136:139], a[24:27], v[188:191]
    v_mfma_f32_16x16x32_bf16 v[188:191], a[140:143], a[28:31], v[188:191]
    v_exp_f32 v176, v176
    v_exp_f32 v177, v177
    v_exp_f32 v178, v178
    v_exp_f32 v179, v179
    v_exp_f32 v180, v180
    v_exp_f32 v181, v181
    v_exp_f32 v182, v182
    v_exp_f32 v183, v183
    v_exp_f32 v184, v184
    v_exp_f32 v185, v185
    v_exp_f32 v186, v186
    v_exp_f32 v187, v187
    v_exp_f32 v188, v188
    v_exp_f32 v189, v189
    v_exp_f32 v190, v190
    v_exp_f32 v191, v191
    v_cvt_pk_bf16_f32 v200, v176, v177
    v_cvt_pk_bf16_f32 v201, v178, v179
    v_cvt_pk_bf16_f32 v202, v180, v181
    v_cvt_pk_bf16_f32 v203, v182, v183
    v_cvt_pk_bf16_f32 v204, v184, v185
    v_cvt_pk_bf16_f32 v205, v186, v187
    v_cvt_pk_bf16_f32 v206, v188, v189
    v_cvt_pk_bf16_f32 v207, v190, v191
    s_nop 1
    s_waitcnt lgkmcnt(0)
    v_mfma_f32_16x16x32_bf16 v[16:19], a[176:179], v[200:203], v[16:19]
    v_mfma_f32_16x16x32_bf16 v[20:23], a[180:183], v[200:203], v[20:23]
    v_mfma_f32_16x16x32_bf16 v[24:27], a[184:187], v[200:203], v[24:27]
    v_mfma_f32_16x16x32_bf16 v[28:31], a[188:191], v[200:203], v[28:31]
    v_mfma_f32_16x16x32_bf16 v[32:35], a[192:195], v[200:203], v[32:35]
    v_mfma_f32_16x16x32_bf16 v[36:39], a[196:199], v[200:203], v[36:39]
    v_mfma_f32_16x16x32_bf16 v[40:43], a[200:203], v[200:203], v[40:43]
    v_mfma_f32_16x16x32_bf16 v[44:47], a[204:207], v[200:203], v[44:47]
    v_mfma_f32_16x16x32_bf16 a[208:211], a[228:231], v[200:203], a[208:211]
    v_mfma_f32_16x16x32_bf16 v[48:51], a[176:179], v[204:207], v[48:51]
    v_mfma_f32_16x16x32_bf16 v[52:55], a[180:183], v[204:207], v[52:55]
    v_mfma_f32_16x16x32_bf16 v[56:59], a[184:187], v[204:207], v[56:59]
    v_mfma_f32_16x16x32_bf16 v[60:63], a[188:191], v[204:207], v[60:63]
    v_mfma_f32_16x16x32_bf16 v[64:67], a[192:195], v[204:207], v[64:67]
    v_mfma_f32_16x16x32_bf16 v[68:71], a[196:199], v[204:207], v[68:71]
    v_mfma_f32_16x16x32_bf16 v[72:75], a[200:203], v[204:207], v[72:75]
    v_mfma_f32_16x16x32_bf16 v[76:79], a[204:207], v[204:207], v[76:79]
    v_mfma_f32_16x16x32_bf16 a[212:215], a[228:231], v[204:207], a[212:215]
    s_waitcnt vmcnt(8)
    s_add_u32 m0, s27, 49152
    s_nop 0
    buffer_load_dwordx4 v248, s[12:15], s26 offen offset:0 nt lds
    buffer_load_dwordx4 v249, s[12:15], s26 offen offset:1024 nt lds
    buffer_load_dwordx4 v250, s[12:15], s26 offen offset:2048 nt lds
    buffer_load_dwordx4 v251, s[12:15], s26 offen offset:3072 nt lds
    s_add_u32 s26, s26, 16384
    s_and_b32 s26, s26, 0x7ffff
    s_sub_u32 s28, s28, 1
    s_cselect_b32 s10, 0, s10
    s_cselect_b32 s14, 0, s14
    s_cmp_lg_u32 s36, 0
    s_cbranch_scc1 L_sq4
    ds_read_b128 v[196:199], v254 offset:8192
    ds_read_b128 v[200:203], v255 offset:8192
    ds_read_b128 v[204:207], v254 offset:10240
    ds_read_b128 v[208:211], v255 offset:10240
    s_waitcnt lgkmcnt(0)
    v_lshlrev_b32 v6, 16, v196
    v_and_b32 v7, s25, v196
    v_mul_f32 v6, s55, v6
    v_mul_f32 v7, s55, v7
    v_cvt_pk_bf16_f32 v196, v6, v7
    v_lshlrev_b32 v8, 16, v197
    v_and_b32 v9, s25, v197
    v_mul_f32 v8, s55, v8
    v_mul_f32 v9, s55, v9
    v_cvt_pk_bf16_f32 v197, v8, v9
    v_accvgpr_write_b32 a32, v196
    v_lshlrev_b32 v10, 16, v198
    v_and_b32 v11, s25, v198
    v_mul_f32 v10, s55, v10
    v_mul_f32 v11, s55, v11
    v_cvt_pk_bf16_f32 v198, v10, v11
    v_accvgpr_write_b32 a33, v197
    v_lshlrev_b32 v12, 16, v199
    v_and_b32 v13, s25, v199
    v_mul_f32 v12, s55, v12
    v_mul_f32 v13, s55, v13
    v_cvt_pk_bf16_f32 v199, v12, v13
    v_accvgpr_write_b32 a34, v198
    v_lshlrev_b32 v6, 16, v200
    v_and_b32 v7, s25, v200
    v_mul_f32 v6, s55, v6
    v_mul_f32 v7, s55, v7
    v_cvt_pk_bf16_f32 v200, v6, v7
    v_accvgpr_write_b32 a35, v199
    v_lshlrev_b32 v8, 16, v201
    v_and_b32 v9, s25, v201
    v_mul_f32 v8, s55, v8
    v_mul_f32 v9, s55, v9
    v_cvt_pk_bf16_f32 v201, v8, v9
    v_accvgpr_write_b32 a36, v200
    v_lshlrev_b32 v10, 16, v202
    v_and_b32 v11, s25, v202
    v_mul_f32 v10, s55, v10
    v_mul_f32 v11, s55, v11
    v_cvt_pk_bf16_f32 v202, v10, v11
    v_accvgpr_write_b32 a37, v201
    v_lshlrev_b32 v12, 16, v203
    v_and_b32 v13, s25, v203
    v_mul_f32 v12, s55, v12
    v_mul_f32 v13, s55, v13
    v_cvt_pk_bf16_f32 v203, v12, v13
    v_accvgpr_write_b32 a38, v202
    v_lshlrev_b32 v6, 16, v204
    v_and_b32 v7, s25, v204
    v_mul_f32 v6, s55, v6
    v_mul_f32 v7, s55, v7
    v_cvt_pk_bf16_f32 v204, v6, v7
    v_accvgpr_write_b32 a39, v203
    v_lshlrev_b32 v8, 16, v205
    v_and_b32 v9, s25, v205
    v_mul_f32 v8, s55, v8
    v_mul_f32 v9, s55, v9
    v_cvt_pk_bf16_f32 v205, v8, v9
    v_accvgpr_write_b32 a40, v204
    v_lshlrev_b32 v10, 16, v206
    v_and_b32 v11, s25, v206
    v_mul_f32 v10, s55, v10
    v_mul_f32 v11, s55, v11
    v_cvt_pk_bf16_f32 v206, v10, v11
    v_accvgpr_write_b32 a41, v205
    v_lshlrev_b32 v12, 16, v207
    v_and_b32 v13, s25, v207
    v_mul_f32 v12, s55, v12
    v_mul_f32 v13, s55, v13
    v_cvt_pk_bf16_f32 v207, v12, v13
    v_accvgpr_write_b32 a42, v206
    v_lshlrev_b32 v6, 16, v208
    v_and_b32 v7, s25, v208
    v_mul_f32 v6, s55, v6
    v_mul_f32 v7, s55, v7
    v_cvt_pk_bf16_f32 v208, v6, v7
    v_accvgpr_write_b32 a43, v207
    v_lshlrev_b32 v8, 16, v209
    v_and_b32 v9, s25, v209
    v_mul_f32 v8, s55, v8
    v_mul_f32 v9, s55, v9
    v_cvt_pk_bf16_f32 v209, v8, v9
    v_accvgpr_write_b32 a44, v208
    v_lshlrev_b32 v10, 16, v210
    v_and_b32 v11, s25, v210
    v_mul_f32 v10, s55, v10
    v_mul_f32 v11, s55, v11
    v_cvt_pk_bf16_f32 v210, v10, v11
    v_accvgpr_write_b32 a45, v209
    v_lshlrev_b32 v12, 16, v211
    v_and_b32 v13, s25, v211
    v_mul_f32 v12, s55, v12
    v_mul_f32 v13, s55, v13
    v_cvt_pk_bf16_f32 v211, v12, v13
    v_accvgpr_write_b32 a46, v210
    v_accvgpr_write_b32 a47, v211
    s_waitcnt lgkmcnt(0)
    s_nop 0
    v_mfma_f32_16x16x32_bf16 v[176:179], a[80:83], a[32:35], 0
    v_mfma_f32_16x16x32_bf16 v[176:179], a[84:87], a[36:39], v[176:179]
    v_mfma_f32_16x16x32_bf16 v[176:179], a[88:91], a[40:43], v[176:179]
    v_mfma_f32_16x16x32_bf16 v[176:179], a[92:95], a[44:47], v[176:179]
    s_nop 7
    v_max3_f32 v8, v176, v177, v178
    v_max_f32 v8, v8, v179
    v_mov_b32 v13, v8
    s_nop 1
    v_permlane16_swap_b32 v8, v13
    s_nop 0
    v_max_f32 v8, v8, v13
    v_mov_b32 v13, v8
    s_nop 1
    v_permlane32_swap_b32 v8, v13
    s_nop 0
    v_max_f32 v8, v8, v13
    v_sub_f32 v220, 0, v8
    v_sub_f32 v221, 0, v8
    v_sub_f32 v222, 0, v8
    v_sub_f32 v223, 0, v8
L_sq4:
    s_nop 1
    v_mfma_f32_16x16x32_bf16 v[176:179], a[80:83], a[32:35], v[220:223]
    v_mfma_f32_16x16x32_bf16 v[176:179], a[84:87], a[36:39], v[176:179]
    v_mfma_f32_16x16x32_bf16 v[176:179], a[88:91], a[40:43], v[176:179]
    v_mfma_f32_16x16x32_bf16 v[176:179], a[92:95], a[44:47], v[176:179]
    v_mfma_f32_16x16x32_bf16 v[180:183], a[96:99], a[32:35], v[220:223]
    v_mfma_f32_16x16x32_bf16 v[180:183], a[100:103], a[36:39], v[180:183]
    v_mfma_f32_16x16x32_bf16 v[180:183], a[104:107], a[40:43], v[180:183]
    v_mfma_f32_16x16x32_bf16 v[180:183], a[108:111], a[44:47], v[180:183]
    v_mfma_f32_16x16x32_bf16 v[184:187], a[112:115], a[32:35], v[220:223]
    v_mfma_f32_16x16x32_bf16 v[184:187], a[116:119], a[36:39], v[184:187]
    v_mfma_f32_16x16x32_bf16 v[184:187], a[120:123], a[40:43], v[184:187]
    v_mfma_f32_16x16x32_bf16 v[184:187], a[124:127], a[44:47], v[184:187]
    v_mfma_f32_16x16x32_bf16 v[188:191], a[128:131], a[32:35], v[220:223]
    v_mfma_f32_16x16x32_bf16 v[188:191], a[132:135], a[36:39], v[188:191]
    v_mfma_f32_16x16x32_bf16 v[188:191], a[136:139], a[40:43], v[188:191]
    v_mfma_f32_16x16x32_bf16 v[188:191], a[140:143], a[44:47], v[188:191]
    v_exp_f32 v176, v176
    v_exp_f32 v177, v177
    v_exp_f32 v178, v178
    v_exp_f32 v179, v179
    v_exp_f32 v180, v180
    v_exp_f32 v181, v181
    v_exp_f32 v182, v182
    v_exp_f32 v183, v183
    v_exp_f32 v184, v184
    v_exp_f32 v185, v185
    v_exp_f32 v186, v186
    v_exp_f32 v187, v187
    v_exp_f32 v188, v188
    v_exp_f32 v189, v189
    v_exp_f32 v190, v190
    v_exp_f32 v191, v191
    v_cvt_pk_bf16_f32 v200, v176, v177
    v_cvt_pk_bf16_f32 v201, v178, v179
    v_cvt_pk_bf16_f32 v202, v180, v181
    v_cvt_pk_bf16_f32 v203, v182, v183
    v_cvt_pk_bf16_f32 v204, v184, v185
    v_cvt_pk_bf16_f32 v205, v186, v187
    v_cvt_pk_bf16_f32 v206, v188, v189
    v_cvt_pk_bf16_f32 v207, v190, v191
    s_nop 1
    v_mfma_f32_16x16x32_bf16 v[80:83], a[144:147], v[200:203], v[80:83]
    v_mfma_f32_16x16x32_bf16 v[84:87], a[148:151], v[200:203], v[84:87]
    v_mfma_f32_16x16x32_bf16 v[88:91], a[152:155], v[200:203], v[88:91]
    v_mfma_f32_16x16x32_bf16 v[92:95], a[156:159], v[200:203], v[92:95]
    v_mfma_f32_16x16x32_bf16 v[96:99], a[160:163], v[200:203], v[96:99]
    v_mfma_f32_16x16x32_bf16 v[100:103], a[164:167], v[200:203], v[100:103]
    v_mfma_f32_16x16x32_bf16 v[104:107], a[168:171], v[200:203], v[104:107]
    v_mfma_f32_16x16x32_bf16 v[108:111], a[172:175], v[200:203], v[108:111]
    v_mfma_f32_16x16x32_bf16 a[216:219], a[228:231], v[200:203], a[216:219]
    v_mfma_f32_16x16x32_bf16 v[80:83], a[176:179], v[204:207], v[80:83]
    v_mfma_f32_16x16x32_bf16 v[84:87], a[180:183], v[204:207], v[84:87]
    v_mfma_f32_16x16x32_bf16 v[88:91], a[184:187], v[204:207], v[88:91]
    v_mfma_f32_16x16x32_bf16 v[92:95], a[188:191], v[204:207], v[92:95]
    v_mfma_f32_16x16x32_bf16 v[96:99], a[192:195], v[204:207], v[96:99]
    v_mfma_f32_16x16x32_bf16 v[100:103], a[196:199], v[204:207], v[100:103]
    v_mfma_f32_16x16x32_bf16 v[104:107], a[200:203], v[204:207], v[104:107]
    v_mfma_f32_16x16x32_bf16 v[108:111], a[204:207], v[204:207], v[108:111]
    v_mfma_f32_16x16x32_bf16 a[216:219], a[228:231], v[204:207], a[216:219]
    s_waitcnt vmcnt(8)
    s_cmp_lg_u32 s36, 0
    s_cbranch_scc1 L_sq5
    ds_read_b128 v[196:199], v254 offset:12288
    ds_read_b128 v[200:203], v255 offset:12288
    ds_read_b128 v[204:207], v254 offset:14336
    ds_read_b128 v[208:211], v255 offset:14336
    s_waitcnt lgkmcnt(0)
    v_lshlrev_b32 v6, 16, v196
    v_and_b32 v7, s25, v196
    v_mul_f32 v6, s55, v6
    v_mul_f32 v7, s55, v7
    v_cvt_pk_bf16_f32 v196, v6, v7
    v_lshlrev_b32 v8, 16, v197
    v_and_b32 v9, s25, v197
    v_mul_f32 v8, s55, v8
    v_mul_f32 v9, s55, v9
    v_cvt_pk_bf16_f32 v197, v8, v9
    v_accvgpr_write_b32 a48, v196
    v_lshlrev_b32 v10, 16, v198
    v_and_b32 v11, s25, v198
    v_mul_f32 v10, s55, v10
    v_mul_f32 v11, s55, v11
    v_cvt_pk_bf16_f32 v198, v10, v11
    v_accvgpr_write_b32 a49, v197
    v_lshlrev_b32 v12, 16, v199
    v_and_b32 v13, s25, v199
    v_mul_f32 v12, s55, v12
    v_mul_f32 v13, s55, v13
    v_cvt_pk_bf16_f32 v199, v12, v13
    v_accvgpr_write_b32 a50, v198
    v_lshlrev_b32 v6, 16, v200
    v_and_b32 v7, s25, v200
    v_mul_f32 v6, s55, v6
    v_mul_f32 v7, s55, v7
    v_cvt_pk_bf16_f32 v200, v6, v7
    v_accvgpr_write_b32 a51, v199
    v_lshlrev_b32 v8, 16, v201
    v_and_b32 v9, s25, v201
    v_mul_f32 v8, s55, v8
    v_mul_f32 v9, s55, v9
    v_cvt_pk_bf16_f32 v201, v8, v9
    v_accvgpr_write_b32 a52, v200
    v_lshlrev_b32 v10, 16, v202
    v_and_b32 v11, s25, v202
    v_mul_f32 v10, s55, v10
    v_mul_f32 v11, s55, v11
    v_cvt_pk_bf16_f32 v202, v10, v11
    v_accvgpr_write_b32 a53, v201
    v_lshlrev_b32 v12, 16, v203
    v_and_b32 v13, s25, v203
    v_mul_f32 v12, s55, v12
    v_mul_f32 v13, s55, v13
    v_cvt_pk_bf16_f32 v203, v12, v13
    v_accvgpr_write_b32 a54, v202
    v_lshlrev_b32 v6, 16, v204
    v_and_b32 v7, s25, v204
    v_mul_f32 v6, s55, v6
    v_mul_f32 v7, s55, v7
    v_cvt_pk_bf16_f32 v204, v6, v7
    v_accvgpr_write_b32 a55, v203
    v_lshlrev_b32 v8, 16, v205
    v_and_b32 v9, s25, v205
    v_mul_f32 v8, s55, v8
    v_mul_f32 v9, s55, v9
    v_cvt_pk_bf16_f32 v205, v8, v9
    v_accvgpr_write_b32 a56, v204
    v_lshlrev_b32 v10, 16, v206
    v_and_b32 v11, s25, v206
    v_mul_f32 v10, s55, v10
    v_mul_f32 v11, s55, v11
    v_cvt_pk_bf16_f32 v206, v10, v11
    v_accvgpr_write_b32 a57, v205
    v_lshlrev_b32 v12, 16, v207
    v_and_b32 v13, s25, v207
    v_mul_f32 v12, s55, v12
    v_mul_f32 v13, s55, v13
    v_cvt_pk_bf16_f32 v207, v12, v13
    v_accvgpr_write_b32 a58, v206
    v_lshlrev_b32 v6, 16, v208
    v_and_b32 v7, s25, v208
    v_mul_f32 v6, s55, v6
    v_mul_f32 v7, s55, v7
    v_cvt_pk_bf16_f32 v208, v6, v7
    v_accvgpr_write_b32 a59, v207
    v_lshlrev_b32 v8, 16, v209
    v_and_b32 v9, s25, v209
    v_mul_f32 v8, s55, v8
    v_mul_f32 v9, s55, v9
    v_cvt_pk_bf16_f32 v209, v8, v9
    v_accvgpr_write_b32 a60, v208
    v_lshlrev_b32 v10, 16, v210
    v_and_b32 v11, s25, v210
    v_mul_f32 v10, s55, v10
    v_mul_f32 v11, s55, v11
    v_cvt_pk_bf16_f32 v210, v10, v11
    v_accvgpr_write_b32 a61, v209
    v_lshlrev_b32 v12, 16, v211
    v_and_b32 v13, s25, v211
    v_mul_f32 v12, s55, v12
    v_mul_f32 v13, s55, v13
    v_cvt_pk_bf16_f32 v211, v12, v13
    v_accvgpr_write_b32 a62, v210
    v_accvgpr_write_b32 a63, v211
    s_waitcnt lgkmcnt(0)
    s_nop 0
    v_mfma_f32_16x16x32_bf16 v[176:179], a[80:83], a[48:51], 0
    v_mfma_f32_16x16x32_bf16 v[176:179], a[84:87], a[52:55], v[176:179]
    v_mfma_f32_16x16x32_bf16 v[176:179], a[88:91], a[56:59], v[176:179]
    v_mfma_f32_16x16x32_bf16 v[176:179], a[92:95], a[60:63], v[176:179]
    s_nop 7
    v_max3_f32 v9, v176, v177, v178
    v_max_f32 v9, v9, v179
    v_mov_b32 v14, v9
    s_nop 1
    v_permlane16_swap_b32 v9, v14
    s_nop 0
    v_max_f32 v9, v9, v14
    v_mov_b32 v14, v9
    s_nop 1
    v_permlane32_swap_b32 v9, v14
    s_nop 0
    v_max_f32 v9, v9, v14
    v_sub_f32 v224, 0, v9
    v_sub_f32 v225, 0, v9
    v_sub_f32 v226, 0, v9
    v_sub_f32 v227, 0, v9
L_sq5:
    s_nop 1
    v_mfma_f32_16x16x32_bf16 v[176:179], a[80:83], a[48:51], v[224:227]
    v_mfma_f32_16x16x32_bf16 v[176:179], a[84:87], a[52:55], v[176:179]
    v_mfma_f32_16x16x32_bf16 v[176:179], a[88:91], a[56:59], v[176:179]
    v_mfma_f32_16x16x32_bf16 v[176:179], a[92:95], a[60:63], v[176:179]
    v_mfma_f32_16x16x32_bf16 v[180:183], a[96:99], a[48:51], v[224:227]
    v_mfma_f32_16x16x32_bf16 v[180:183], a[100:103], a[52:55], v[180:183]
    v_mfma_f32_16x16x32_bf16 v[180:183], a[104:107], a[56:59], v[180:183]
    v_mfma_f32_16x16x32_bf16 v[180:183], a[108:111], a[60:63], v[180:183]
    v_mfma_f32_16x16x32_bf16 v[184:187], a[112:115], a[48:51], v[224:227]
    v_mfma_f32_16x16x32_bf16 v[184:187], a[116:119], a[52:55], v[184:187]
    v_mfma_f32_16x16x32_bf16 v[184:187], a[120:123], a[56:59], v[184:187]
    v_mfma_f32_16x16x32_bf16 v[184:187], a[124:127], a[60:63], v[184:187]
    v_mfma_f32_16x16x32_bf16 v[188:191], a[128:131], a[48:51], v[224:227]
    v_mfma_f32_16x16x32_bf16 v[188:191], a[132:135], a[52:55], v[188:191]
    v_mfma_f32_16x16x32_bf16 v[188:191], a[136:139], a[56:59], v[188:191]
    v_mfma_f32_16x16x32_bf16 v[188:191], a[140:143], a[60:63], v[188:191]
    v_exp_f32 v176, v176
    v_exp_f32 v177, v177
    v_exp_f32 v178, v178
    v_exp_f32 v179, v179
    v_exp_f32 v180, v180
    v_exp_f32 v181, v181
    v_exp_f32 v182, v182
    v_exp_f32 v183, v183
    v_exp_f32 v184, v184
    v_exp_f32 v185, v185
    v_exp_f32 v186, v186
    v_exp_f32 v187, v187
    v_exp_f32 v188, v188
    v_exp_f32 v189, v189
    v_exp_f32 v190, v190
    v_exp_f32 v191, v191
    v_cvt_pk_bf16_f32 v200, v176, v177
    v_cvt_pk_bf16_f32 v201, v178, v179
    v_cvt_pk_bf16_f32 v202, v180, v181
    v_cvt_pk_bf16_f32 v203, v182, v183
    v_cvt_pk_bf16_f32 v204, v184, v185
    v_cvt_pk_bf16_f32 v205, v186, v187
    v_cvt_pk_bf16_f32 v206, v188, v189
    v_cvt_pk_bf16_f32 v207, v190, v191
    s_nop 1
    v_mfma_f32_16x16x32_bf16 v[112:115], a[144:147], v[200:203], v[112:115]
    v_mfma_f32_16x16x32_bf16 v[116:119], a[148:151], v[200:203], v[116:119]
    v_mfma_f32_16x16x32_bf16 v[120:123], a[152:155], v[200:203], v[120:123]
    v_mfma_f32_16x16x32_bf16 v[124:127], a[156:159], v[200:203], v[124:127]
    v_mfma_f32_16x16x32_bf16 v[128:131], a[160:163], v[200:203], v[128:131]
    v_mfma_f32_16x16x32_bf16 v[132:135], a[164:167], v[200:203], v[132:135]
    v_mfma_f32_16x16x32_bf16 v[136:139], a[168:171], v[200:203], v[136:139]
    v_mfma_f32_16x16x32_bf16 v[140:143], a[172:175], v[200:203], v[140:143]
    v_mfma_f32_16x16x32_bf16 a[220:223], a[228:231], v[200:203], a[220:223]
    v_mfma_f32_16x16x32_bf16 v[112:115], a[176:179], v[204:207], v[112:115]
    v_mfma_f32_16x16x32_bf16 v[116:119], a[180:183], v[204:207], v[116:119]
    v_mfma_f32_16x16x32_bf16 v[120:123], a[184:187], v[204:207], v[120:123]
    v_mfma_f32_16x16x32_bf16 v[124:127], a[188:191], v[204:207], v[124:127]
    v_mfma_f32_16x16x32_bf16 v[128:131], a[192:195], v[204:207], v[128:131]
    v_mfma_f32_16x16x32_bf16 v[132:135], a[196:199], v[204:207], v[132:135]
    v_mfma_f32_16x16x32_bf16 v[136:139], a[200:203], v[204:207], v[136:139]
    v_mfma_f32_16x16x32_bf16 v[140:143], a[204:207], v[204:207], v[140:143]
    v_mfma_f32_16x16x32_bf16 a[220:223], a[228:231], v[204:207], a[220:223]
    v_mfma_f32_16x16x32_bf16 v[192:195], a[112:115], a[64:67], v[228:231]
    v_mfma_f32_16x16x32_bf16 v[192:195], a[116:119], a[68:71], v[192:195]
    v_mfma_f32_16x16x32_bf16 v[192:195], a[120:123], a[72:75], v[192:195]
    v_mfma_f32_16x16x32_bf16 v[192:195], a[124:127], a[76:79], v[192:195]
    v_mfma_f32_16x16x32_bf16 v[196:199], a[128:131], a[64:67], v[228:231]
    v_mfma_f32_16x16x32_bf16 v[196:199], a[132:135], a[68:71], v[196:199]
    v_mfma_f32_16x16x32_bf16 v[196:199], a[136:139], a[72:75], v[196:199]
    v_mfma_f32_16x16x32_bf16 v[196:199], a[140:143], a[76:79], v[196:199]
    s_waitcnt vmcnt(0)
    s_barrier
    ds_read_b128 a[80:83], v232 offset:32768
    ds_read_b128 a[84:87], v233 offset:32768
    ds_read_b128 a[88:91], v232 offset:36864
    ds_read_b128 a[92:95], v233 offset:36864
    ds_read_b128 a[96:99], v232 offset:34816
    ds_read_b128 a[100:103], v233 offset:34816
    ds_read_b128 a[104:107], v232 offset:38912
    ds_read_b128 a[108:111], v233 offset:38912
    ds_read_b64_tr_b16 a[144:145], v236 offset:49152
    ds_read_b64_tr_b16 a[146:147], v236 offset:51200
    ds_read_b64_tr_b16 a[148:149], v237 offset:49152
    ds_read_b64_tr_b16 a[150:151], v237 offset:51200
    ds_read_b64_tr_b16 a[152:153], v238 offset:49152
    ds_read_b64_tr_b16 a[154:155], v238 offset:51200
    ds_read_b64_tr_b16 a[156:157], v239 offset:49152
    ds_read_b64_tr_b16 a[158:159], v239 offset:51200
    ds_read_b64_tr_b16 a[160:161], v236 offset:53248
    ds_read_b64_tr_b16 a[162:163], v236 offset:55296
    ds_read_b64_tr_b16 a[164:165], v237 offset:53248
    ds_read_b64_tr_b16 a[166:167], v237 offset:55296
    ds_read_b64_tr_b16 a[168:169], v238 offset:53248
    ds_read_b64_tr_b16 a[170:171], v238 offset:55296
    ds_read_b64_tr_b16 a[172:173], v239 offset:53248
    ds_read_b64_tr_b16 a[174:175], v239 offset:55296
    s_mov_b32 m0, s27
    s_nop 0
    buffer_load_dwordx4 v244, s[8:11], s26 offen offset:0 nt lds
    buffer_load_dwordx4 v245, s[8:11], s26 offen offset:1024 nt lds
    buffer_load_dwordx4 v246, s[8:11], s26 offen offset:2048 nt lds
    buffer_load_dwordx4 v247, s[8:11], s26 offen offset:3072 nt lds
    s_add_u32 m0, s27, 16384
    s_nop 0
    buffer_load_dwordx4 v248, s[12:15], s26 offen offset:0 nt lds
    buffer_load_dwordx4 v249, s[12:15], s26 offen offset:1024 nt lds
    buffer_load_dwordx4 v250, s[12:15], s26 offen offset:2048 nt lds
    buffer_load_dwordx4 v251, s[12:15], s26 offen offset:3072 nt lds
    s_add_u32 s26, s26, 16384
    s_and_b32 s26, s26, 0x7ffff
    s_sub_u32 s28, s28, 1
    s_cselect_b32 s10, 0, s10
    s_cselect_b32 s14, 0, s14
    v_exp_f32 v192, v192
    v_exp_f32 v193, v193
    v_exp_f32 v194, v194
    v_exp_f32 v195, v195
    v_exp_f32 v196, v196
    s_nop 0
    v_cvt_pk_bf16_f32 v208, v192, v193
    v_cvt_pk_bf16_f32 v209, v194, v195
    s_mov_b32 s35, 15
    s_waitcnt lgkmcnt(0)
.p2align 6
L_loop:
    v_mfma_f32_16x16x32_bf16 v[176:179], a[80:83], a[0:3], v[212:215]
    v_exp_f32_e64 v197, v197
    v_mfma_f32_16x16x32_bf16 v[176:179], a[84:87], a[4:7], v[176:179]
    ds_read_b128 a[112:115], v234 offset:32768
    v_cvt_pk_bf16_f32 v210, v196, v197
    v_mfma_f32_16x16x32_bf16 v[176:179], a[88:91], a[8:11], v[176:179]
    v_exp_f32_e64 v198, v198
    v_mfma_f32_16x16x32_bf16 v[176:179], a[92:95], a[12:15], v[176:179]
    ds_read_b128 a[116:119], v235 offset:32768
    ds_read_b128 a[120:123], v234 offset:36864
    v_mfma_f32_16x16x32_bf16 v[180:183], a[96:99], a[0:3], v[212:215]
    v_exp_f32_e64 v199, v199
    v_mfma_f32_16x16x32_bf16 v[180:183], a[100:103], a[4:7], v[180:183]
    ds_read_b128 a[124:127], v235 offset:36864
    v_cvt_pk_bf16_f32 v211, v198, v199
    v_mfma_f32_16x16x32_bf16 v[180:183], a[104:107], a[8:11], v[180:183]
    ds_read_b128 a[128:131], v234 offset:34816
    ds_read_b128 a[132:135], v235 offset:34816
    v_mfma_f32_16x16x32_bf16 v[180:183], a[108:111], a[12:15], v[180:183]
    v_exp_f32_e64 v176, v176
    v_mfma_f32_16x16x32_bf16 v[144:147], a[176:179], v[208:211], v[144:147]
    ds_read_b128 a[136:139], v234 offset:38912
    ds_read_b128 a[140:143], v235 offset:38912
    v_mfma_f32_16x16x32_bf16 v[148:151], a[180:183], v[208:211], v[148:151]
    v_exp_f32_e64 v177, v177
    v_mfma_f32_16x16x32_bf16 v[152:155], a[184:187], v[208:211], v[152:155]
    ds_read_b64_tr_b16 a[176:177], v240 offset:49152
    v_cvt_pk_bf16_f32 v200, v176, v177
    v_mfma_f32_16x16x32_bf16 v[156:159], a[188:191], v[208:211], v[156:159]
    v_exp_f32_e64 v178, v178
    v_mfma_f32_16x16x32_bf16 v[160:163], a[192:195], v[208:211], v[160:163]
    ds_read_b64_tr_b16 a[178:179], v240 offset:51200
    ds_read_b64_tr_b16 a[180:181], v241 offset:49152
    v_mfma_f32_16x16x32_bf16 v[164:167], a[196:199], v[208:211], v[164:167]
    v_exp_f32_e64 v179, v179
    v_mfma_f32_16x16x32_bf16 v[168:171], a[200:203], v[208:211], v[168:171]
    ds_read_b64_tr_b16 a[182:183], v241 offset:51200
    v_cvt_pk_bf16_f32 v201, v178, v179
    v_mfma_f32_16x16x32_bf16 v[172:175], a[204:207], v[208:211], v[172:175]
    v_exp_f32_e64 v180, v180
    v_mfma_f32_16x16x32_bf16 a[224:227], a[228:231], v[208:211], a[224:227]
    ds_read_b64_tr_b16 a[184:185], v242 offset:49152
    ds_read_b64_tr_b16 a[186:187], v242 offset:51200
    v_mfma_f32_16x16x32_bf16 v[184:187], a[80:83], a[16:19], v[216:219]
    v_exp_f32_e64 v181, v181
    v_mfma_f32_16x16x32_bf16 v[184:187], a[84:87], a[20:23], v[184:187]
    ds_read_b64_tr_b16 a[188:189], v243 offset:49152
    v_cvt_pk_bf16_f32 v202, v180, v181
    v_mfma_f32_16x16x32_bf16 v[184:187], a[88:91], a[24:27], v[184:187]
    v_exp_f32_e64 v182, v182
    v_mfma_f32_16x16x32_bf16 v[184:187], a[92:95], a[28:31], v[184:187]
    ds_read_b64_tr_b16 a[190:191], v243 offset:51200
    ds_read_b64_tr_b16 a[192:193], v240 offset:53248
    v_mfma_f32_16x16x32_bf16 v[188:191], a[96:99], a[16:19], v[216:219]
    v_exp_f32_e64 v183, v183
    v_mfma_f32_16x16x32_bf16 v[188:191], a[100:103], a[20:23], v[188:191]
    ds_read_b64_tr_b16 a[194:195], v240 offset:55296
    v_cvt_pk_bf16_f32 v203, v182, v183
    v_mfma_f32_16x16x32_bf16 v[188:191], a[104:107], a[24:27], v[188:191]
    ds_read_b64_tr_b16 a[196:197], v241 offset:53248
    ds_read_b64_tr_b16 a[198:199], v241 offset:55296
    v_mfma_f32_16x16x32_bf16 v[188:191], a[108:111], a[28:31], v[188:191]
    v_exp_f32_e64 v184, v184
    v_mfma_f32_16x16x32_bf16 v[16:19], a[144:147], v[200:203], v[16:19]
    ds_read_b64_tr_b16 a[200:201], v242 offset:53248
    ds_read_b64_tr_b16 a[202:203], v242 offset:55296
    v_mfma_f32_16x16x32_bf16 v[20:23], a[148:151], v[200:203], v[20:23]
    v_exp_f32_e64 v185, v185
    v_mfma_f32_16x16x32_bf16 v[24:27], a[152:155], v[200:203], v[24:27]
    ds_read_b64_tr_b16 a[204:205], v243 offset:53248
    v_cvt_pk_bf16_f32 v204, v184, v185
    v_mfma_f32_16x16x32_bf16 v[28:31], a[156:159], v[200:203], v[28:31]
    v_exp_f32_e64 v186, v186
    v_mfma_f32_16x16x32_bf16 v[32:35], a[160:163], v[200:203], v[32:35]
    ds_read_b64_tr_b16 a[206:207], v243 offset:55296
    v_mfma_f32_16x16x32_bf16 v[36:39], a[164:167], v[200:203], v[36:39]
    v_exp_f32_e64 v187, v187
    v_mfma_f32_16x16x32_bf16 v[40:43], a[168:171], v[200:203], v[40:43]
    v_cvt_pk_bf16_f32 v205, v186, v187
    v_mfma_f32_16x16x32_bf16 v[44:47], a[172:175], v[200:203], v[44:47]
    v_exp_f32_e64 v188, v188
    v_mfma_f32_16x16x32_bf16 a[208:211], a[228:231], v[200:203], a[208:211]
    v_mfma_f32_16x16x32_bf16 v[192:195], a[80:83], a[32:35], v[220:223]
    v_exp_f32_e64 v189, v189
    v_mfma_f32_16x16x32_bf16 v[192:195], a[84:87], a[36:39], v[192:195]
    v_cvt_pk_bf16_f32 v206, v188, v189
    v_mfma_f32_16x16x32_bf16 v[192:195], a[88:91], a[40:43], v[192:195]
    v_exp_f32_e64 v190, v190
    v_mfma_f32_16x16x32_bf16 v[192:195], a[92:95], a[44:47], v[192:195]
    s_nop 0
    v_mfma_f32_16x16x32_bf16 v[196:199], a[96:99], a[32:35], v[220:223]
    s_nop 0
    v_exp_f32_e64 v191, v191
    v_mfma_f32_16x16x32_bf16 v[196:199], a[100:103], a[36:39], v[196:199]
    v_cvt_pk_bf16_f32 v207, v190, v191
    v_mfma_f32_16x16x32_bf16 v[196:199], a[104:107], a[40:43], v[196:199]
    v_mfma_f32_16x16x32_bf16 v[196:199], a[108:111], a[44:47], v[196:199]
    v_exp_f32_e64 v192, v192
    v_mfma_f32_16x16x32_bf16 v[48:51], a[144:147], v[204:207], v[48:51]
    v_mfma_f32_16x16x32_bf16 v[52:55], a[148:151], v[204:207], v[52:55]
    v_exp_f32_e64 v193, v193
    v_mfma_f32_16x16x32_bf16 v[56:59], a[152:155], v[204:207], v[56:59]
    v_cvt_pk_bf16_f32 v208, v192, v193
    v_mfma_f32_16x16x32_bf16 v[60:63], a[156:159], v[204:207], v[60:63]
    v_exp_f32_e64 v194, v194
    v_mfma_f32_16x16x32_bf16 v[64:67], a[160:163], v[204:207], v[64:67]
    v_mfma_f32_16x16x32_bf16 v[68:71], a[164:167], v[204:207], v[68:71]
    v_exp_f32_e64 v195, v195
    v_mfma_f32_16x16x32_bf16 v[72:75], a[168:171], v[204:207], v[72:75]
    v_cvt_pk_bf16_f32 v209, v194, v195
    v_mfma_f32_16x16x32_bf16 v[76:79], a[172:175], v[204:207], v[76:79]
    v_exp_f32_e64 v196, v196
    v_mfma_f32_16x16x32_bf16 a[212:215], a[228:231], v[204:207], a[212:215]
    v_mfma_f32_16x16x32_bf16 v[176:179], a[80:83], a[48:51], v[224:227]
    v_exp_f32_e64 v197, v197
    v_mfma_f32_16x16x32_bf16 v[176:179], a[84:87], a[52:55], v[176:179]
    v_cvt_pk_bf16_f32 v210, v196, v197
    v_mfma_f32_16x16x32_bf16 v[176:179], a[88:91], a[56:59], v[176:179]
    v_exp_f32_e64 v198, v198
    v_mfma_f32_16x16x32_bf16 v[176:179], a[92:95], a[60:63], v[176:179]
    s_nop 0
    v_mfma_f32_16x16x32_bf16 v[180:183], a[96:99], a[48:51], v[224:227]
    s_nop 0
    v_exp_f32_e64 v199, v199
    v_mfma_f32_16x16x32_bf16 v[180:183], a[100:103], a[52:55], v[180:183]
    v_cvt_pk_bf16_f32 v211, v198, v199
    v_mfma_f32_16x16x32_bf16 v[180:183], a[104:107], a[56:59], v[180:183]
    v_mfma_f32_16x16x32_bf16 v[180:183], a[108:111], a[60:63], v[180:183]
    v_exp_f32_e64 v176, v176
    v_mfma_f32_16x16x32_bf16 v[80:83], a[144:147], v[208:211], v[80:83]
    v_mfma_f32_16x16x32_bf16 v[84:87], a[148:151], v[208:211], v[84:87]
    v_exp_f32_e64 v177, v177
    v_mfma_f32_16x16x32_bf16 v[88:91], a[152:155], v[208:211], v[88:91]
    v_cvt_pk_bf16_f32 v200, v176, v177
    v_mfma_f32_16x16x32_bf16 v[92:95], a[156:159], v[208:211], v[92:95]
    v_exp_f32_e64 v178, v178
    v_mfma_f32_16x16x32_bf16 v[96:99], a[160:163], v[208:211], v[96:99]
    s_waitcnt vmcnt(0)
    v_mfma_f32_16x16x32_bf16 v[100:103], a[164:167], v[208:211], v[100:103]
    s_waitcnt lgkmcnt(0)
    v_exp_f32_e64 v179, v179
    v_mfma_f32_16x16x32_bf16 v[104:107], a[168:171], v[208:211], v[104:107]
    s_barrier
    v_cvt_pk_bf16_f32 v201, v178, v179
    v_mfma_f32_16x16x32_bf16 v[108:111], a[172:175], v[208:211], v[108:111]
    s_add_u32 m0, s27, 32768
    v_exp_f32 v180, v180
    v_mfma_f32_16x16x32_bf16 a[216:219], a[228:231], v[208:211], a[216:219]
    ds_read_b128 a[80:83], v232 offset:0
    ds_read_b128 a[84:87], v233 offset:0
    v_mfma_f32_16x16x32_bf16 v[184:187], a[112:115], a[0:3], v[212:215]
    v_exp_f32_e64 v181, v181
    v_mfma_f32_16x16x32_bf16 v[184:187], a[116:119], a[4:7], v[184:187]
    ds_read_b128 a[88:91], v232 offset:4096
    v_cvt_pk_bf16_f32 v202, v180, v181
    v_mfma_f32_16x16x32_bf16 v[184:187], a[120:123], a[8:11], v[184:187]
    v_exp_f32_e64 v182, v182
    v_mfma_f32_16x16x32_bf16 v[184:187], a[124:127], a[12:15], v[184:187]
    buffer_load_dwordx4 v244, s[8:11], s26 offen offset:0 nt lds
    v_mfma_f32_16x16x32_bf16 v[188:191], a[128:131], a[0:3], v[212:215]
    v_exp_f32_e64 v183, v183
    v_mfma_f32_16x16x32_bf16 v[188:191], a[132:135], a[4:7], v[188:191]
    ds_read_b128 a[92:95], v233 offset:4096
    v_cvt_pk_bf16_f32 v203, v182, v183
    v_mfma_f32_16x16x32_bf16 v[188:191], a[136:139], a[8:11], v[188:191]
    ds_read_b128 a[96:99], v232 offset:2048
    ds_read_b128 a[100:103], v233 offset:2048
    v_mfma_f32_16x16x32_bf16 v[188:191], a[140:143], a[12:15], v[188:191]
    v_exp_f32_e64 v184, v184
    v_mfma_f32_16x16x32_bf16 v[112:115], a[144:147], v[200:203], v[112:115]
    ds_read_b128 a[104:107], v232 offset:6144
    ds_read_b128 a[108:111], v233 offset:6144
    v_mfma_f32_16x16x32_bf16 v[116:119], a[148:151], v[200:203], v[116:119]
    v_exp_f32_e64 v185, v185
    v_mfma_f32_16x16x32_bf16 v[120:123], a[152:155], v[200:203], v[120:123]
    ds_read_b64_tr_b16 a[144:145], v236 offset:16384
    v_cvt_pk_bf16_f32 v204, v184, v185
    v_mfma_f32_16x16x32_bf16 v[124:127], a[156:159], v[200:203], v[124:127]
    v_exp_f32_e64 v186, v186
    v_mfma_f32_16x16x32_bf16 v[128:131], a[160:163], v[200:203], v[128:131]
    buffer_load_dwordx4 v245, s[8:11], s26 offen offset:1024 nt lds
    v_mfma_f32_16x16x32_bf16 v[132:135], a[164:167], v[200:203], v[132:135]
    v_exp_f32_e64 v187, v187
    v_mfma_f32_16x16x32_bf16 v[136:139], a[168:171], v[200:203], v[136:139]
    ds_read_b64_tr_b16 a[146:147], v236 offset:18432
    v_cvt_pk_bf16_f32 v205, v186, v187
    v_mfma_f32_16x16x32_bf16 v[140:143], a[172:175], v[200:203], v[140:143]
    v_exp_f32_e64 v188, v188
    v_mfma_f32_16x16x32_bf16 a[220:223], a[228:231], v[200:203], a[220:223]
    ds_read_b64_tr_b16 a[148:149], v237 offset:16384
    ds_read_b64_tr_b16 a[150:151], v237 offset:18432
    v_mfma_f32_16x16x32_bf16 v[192:195], a[112:115], a[16:19], v[216:219]
    v_exp_f32_e64 v189, v189
    v_mfma_f32_16x16x32_bf16 v[192:195], a[116:119], a[20:23], v[192:195]
    ds_read_b64_tr_b16 a[152:153], v238 offset:16384
    v_cvt_pk_bf16_f32 v206, v188, v189
    v_mfma_f32_16x16x32_bf16 v[192:195], a[120:123], a[24:27], v[192:195]
    v_exp_f32_e64 v190, v190
    v_mfma_f32_16x16x32_bf16 v[192:195], a[124:127], a[28:31], v[192:195]
    buffer_load_dwordx4 v246, s[8:11], s26 offen offset:2048 nt lds
    v_mfma_f32_16x16x32_bf16 v[196:199], a[128:131], a[16:19], v[216:219]
    v_exp_f32_e64 v191, v191
    v_mfma_f32_16x16x32_bf16 v[196:199], a[132:135], a[20:23], v[196:199]
    ds_read_b64_tr_b16 a[154:155], v238 offset:18432
    v_cvt_pk_bf16_f32 v207, v190, v191
    v_mfma_f32_16x16x32_bf16 v[196:199], a[136:139], a[24:27], v[196:199]
    ds_read_b64_tr_b16 a[156:157], v239 offset:16384
    ds_read_b64_tr_b16 a[158:159], v239 offset:18432
    v_mfma_f32_16x16x32_bf16 v[196:199], a[140:143], a[28:31], v[196:199]
    v_exp_f32_e64 v192, v192
    v_mfma_f32_16x16x32_bf16 v[16:19], a[176:179], v[204:207], v[16:19]
    ds_read_b64_tr_b16 a[160:161], v236 offset:20480
    ds_read_b64_tr_b16 a[162:163], v236 offset:22528
    v_mfma_f32_16x16x32_bf16 v[20:23], a[180:183], v[204:207], v[20:23]
    v_exp_f32_e64 v193, v193
    v_mfma_f32_16x16x32_bf16 v[24:27], a[184:187], v[204:207], v[24:27]
    ds_read_b64_tr_b16 a[164:165], v237 offset:20480
    v_cvt_pk_bf16_f32 v208, v192, v193
    v_mfma_f32_16x16x32_bf16 v[28:31], a[188:191], v[204:207], v[28:31]
    v_exp_f32_e64 v194, v194
    v_mfma_f32_16x16x32_bf16 v[32:35], a[192:195], v[204:207], v[32:35]
    buffer_load_dwordx4 v247, s[8:11], s26 offen offset:3072 nt lds
    v_mfma_f32_16x16x32_bf16 v[36:39], a[196:199], v[204:207], v[36:39]
    s_add_u32 m0, s27, 49152
    v_exp_f32_e64 v195, v195
    v_mfma_f32_16x16x32_bf16 v[40:43], a[200:203], v[204:207], v[40:43]
    ds_read_b64_tr_b16 a[166:167], v237 offset:22528
    v_cvt_pk_bf16_f32 v209, v194, v195
    v_mfma_f32_16x16x32_bf16 v[44:47], a[204:207], v[204:207], v[44:47]
    v_exp_f32_e64 v196, v196
    v_mfma_f32_16x16x32_bf16 a[208:211], a[228:231], v[204:207], a[208:211]
    ds_read_b64_tr_b16 a[168:169], v238 offset:20480
    ds_read_b64_tr_b16 a[170:171], v238 offset:22528
    v_mfma_f32_16x16x32_bf16 v[176:179], a[112:115], a[32:35], v[220:223]
    v_exp_f32_e64 v197, v197
    v_mfma_f32_16x16x32_bf16 v[176:179], a[116:119], a[36:39], v[176:179]
    ds_read_b64_tr_b16 a[172:173], v239 offset:20480
    v_cvt_pk_bf16_f32 v210, v196, v197
    v_mfma_f32_16x16x32_bf16 v[176:179], a[120:123], a[40:43], v[176:179]
    v_exp_f32_e64 v198, v198
    v_mfma_f32_16x16x32_bf16 v[176:179], a[124:127], a[44:47], v[176:179]
    buffer_load_dwordx4 v248, s[12:15], s26 offen offset:0 nt lds
    v_mfma_f32_16x16x32_bf16 v[180:183], a[128:131], a[32:35], v[220:223]
    v_exp_f32_e64 v199, v199
    v_mfma_f32_16x16x32_bf16 v[180:183], a[132:135], a[36:39], v[180:183]
    ds_read_b64_tr_b16 a[174:175], v239 offset:22528
    v_cvt_pk_bf16_f32 v211, v198, v199
    v_mfma_f32_16x16x32_bf16 v[180:183], a[136:139], a[40:43], v[180:183]
    v_mfma_f32_16x16x32_bf16 v[180:183], a[140:143], a[44:47], v[180:183]
    v_exp_f32_e64 v176, v176
    v_mfma_f32_16x16x32_bf16 v[48:51], a[176:179], v[208:211], v[48:51]
    v_mfma_f32_16x16x32_bf16 v[52:55], a[180:183], v[208:211], v[52:55]
    v_exp_f32_e64 v177, v177
    v_mfma_f32_16x16x32_bf16 v[56:59], a[184:187], v[208:211], v[56:59]
    v_cvt_pk_bf16_f32 v200, v176, v177
    v_mfma_f32_16x16x32_bf16 v[60:63], a[188:191], v[208:211], v[60:63]
    v_exp_f32_e64 v178, v178
    v_mfma_f32_16x16x32_bf16 v[64:67], a[192:195], v[208:211], v[64:67]
    buffer_load_dwordx4 v249, s[12:15], s26 offen offset:1024 nt lds
    v_mfma_f32_16x16x32_bf16 v[68:71], a[196:199], v[208:211], v[68:71]
    v_exp_f32_e64 v179, v179
    v_mfma_f32_16x16x32_bf16 v[72:75], a[200:203], v[208:211], v[72:75]
    v_cvt_pk_bf16_f32 v201, v178, v179
    v_mfma_f32_16x16x32_bf16 v[76:79], a[204:207], v[208:211], v[76:79]
    v_exp_f32_e64 v180, v180
    v_mfma_f32_16x16x32_bf16 a[212:215], a[228:231], v[208:211], a[212:215]
    v_mfma_f32_16x16x32_bf16 v[184:187], a[112:115], a[48:51], v[224:227]
    v_exp_f32_e64 v181, v181
    v_mfma_f32_16x16x32_bf16 v[184:187], a[116:119], a[52:55], v[184:187]
    v_cvt_pk_bf16_f32 v202, v180, v181
    v_mfma_f32_16x16x32_bf16 v[184:187], a[120:123], a[56:59], v[184:187]
    v_exp_f32_e64 v182, v182
    v_mfma_f32_16x16x32_bf16 v[184:187], a[124:127], a[60:63], v[184:187]
    buffer_load_dwordx4 v250, s[12:15], s26 offen offset:2048 nt lds
    v_mfma_f32_16x16x32_bf16 v[188:191], a[128:131], a[48:51], v[224:227]
    s_nop 0
    v_exp_f32 v183, v183
    v_mfma_f32_16x16x32_bf16 v[188:191], a[132:135], a[52:55], v[188:191]
    v_cvt_pk_bf16_f32 v203, v182, v183
    v_mfma_f32_16x16x32_bf16 v[188:191], a[136:139], a[56:59], v[188:191]
    v_mfma_f32_16x16x32_bf16 v[188:191], a[140:143], a[60:63], v[188:191]
    v_exp_f32_e64 v184, v184
    v_mfma_f32_16x16x32_bf16 v[80:83], a[176:179], v[200:203], v[80:83]
    v_mfma_f32_16x16x32_bf16 v[84:87], a[180:183], v[200:203], v[84:87]
    v_exp_f32_e64 v185, v185
    v_mfma_f32_16x16x32_bf16 v[88:91], a[184:187], v[200:203], v[88:91]
    v_cvt_pk_bf16_f32 v204, v184, v185
    v_mfma_f32_16x16x32_bf16 v[92:95], a[188:191], v[200:203], v[92:95]
    v_exp_f32_e64 v186, v186
    v_mfma_f32_16x16x32_bf16 v[96:99], a[192:195], v[200:203], v[96:99]
    buffer_load_dwordx4 v251, s[12:15], s26 offen offset:3072 nt lds
    v_mfma_f32_16x16x32_bf16 v[100:103], a[196:199], v[200:203], v[100:103]
    s_add_u32 s26, s26, 16384
    v_exp_f32_e64 v187, v187
    v_mfma_f32_16x16x32_bf16 v[104:107], a[200:203], v[200:203], v[104:107]
    s_and_b32 s26, s26, 0x7ffff
    v_cvt_pk_bf16_f32 v205, v186, v187
    v_mfma_f32_16x16x32_bf16 v[108:111], a[204:207], v[200:203], v[108:111]
    s_sub_u32 s28, s28, 1
    v_exp_f32 v188, v188
    v_mfma_f32_16x16x32_bf16 a[216:219], a[228:231], v[200:203], a[216:219]
    s_cselect_b32 s10, 0, s10
    v_mfma_f32_16x16x32_bf16 v[192:195], a[112:115], a[64:67], v[228:231]
    s_cselect_b32 s14, 0, s14
    v_exp_f32_e64 v189, v189
    v_mfma_f32_16x16x32_bf16 v[192:195], a[116:119], a[68:71], v[192:195]
    v_cvt_pk_bf16_f32 v206, v188, v189
    v_mfma_f32_16x16x32_bf16 v[192:195], a[120:123], a[72:75], v[192:195]
    v_exp_f32_e64 v190, v190
    v_mfma_f32_16x16x32_bf16 v[192:195], a[124:127], a[76:79], v[192:195]
    s_nop 0
    v_mfma_f32_16x16x32_bf16 v[196:199], a[128:131], a[64:67], v[228:231]
    s_nop 0
    v_exp_f32_e64 v191, v191
    v_mfma_f32_16x16x32_bf16 v[196:199], a[132:135], a[68:71], v[196:199]
    v_cvt_pk_bf16_f32 v207, v190, v191
    v_mfma_f32_16x16x32_bf16 v[196:199], a[136:139], a[72:75], v[196:199]
    v_mfma_f32_16x16x32_bf16 v[196:199], a[140:143], a[76:79], v[196:199]
    v_exp_f32_e64 v192, v192
    v_mfma_f32_16x16x32_bf16 v[112:115], a[176:179], v[204:207], v[112:115]
    v_mfma_f32_16x16x32_bf16 v[116:119], a[180:183], v[204:207], v[116:119]
    v_exp_f32_e64 v193, v193
    v_mfma_f32_16x16x32_bf16 v[120:123], a[184:187], v[204:207], v[120:123]
    v_cvt_pk_bf16_f32 v208, v192, v193
    v_mfma_f32_16x16x32_bf16 v[124:127], a[188:191], v[204:207], v[124:127]
    v_exp_f32_e64 v194, v194
    v_mfma_f32_16x16x32_bf16 v[128:131], a[192:195], v[204:207], v[128:131]
    v_mfma_f32_16x16x32_bf16 v[132:135], a[196:199], v[204:207], v[132:135]
    v_exp_f32_e64 v195, v195
    v_mfma_f32_16x16x32_bf16 v[136:139], a[200:203], v[204:207], v[136:139]
    v_cvt_pk_bf16_f32 v209, v194, v195
    v_mfma_f32_16x16x32_bf16 v[140:143], a[204:207], v[204:207], v[140:143]
    v_exp_f32_e64 v196, v196
    v_mfma_f32_16x16x32_bf16 a[220:223], a[228:231], v[204:207], a[220:223]
    s_waitcnt lgkmcnt(0)
    s_nop 0
    v_mfma_f32_16x16x32_bf16 v[176:179], a[80:83], a[0:3], v[212:215]
    v_exp_f32_e64 v197, v197
    v_mfma_f32_16x16x32_bf16 v[176:179], a[84:87], a[4:7], v[176:179]
    ds_read_b128 a[112:115], v234 offset:0
    v_cvt_pk_bf16_f32 v210, v196, v197
    v_mfma_f32_16x16x32_bf16 v[176:179], a[88:91], a[8:11], v[176:179]
    v_exp_f32_e64 v198, v198
    v_mfma_f32_16x16x32_bf16 v[176:179], a[92:95], a[12:15], v[176:179]
    ds_read_b128 a[116:119], v235 offset:0
    ds_read_b128 a[120:123], v234 offset:4096
    v_mfma_f32_16x16x32_bf16 v[180:183], a[96:99], a[0:3], v[212:215]
    v_exp_f32_e64 v199, v199
    v_mfma_f32_16x16x32_bf16 v[180:183], a[100:103], a[4:7], v[180:183]
    ds_read_b128 a[124:127], v235 offset:4096
    v_cvt_pk_bf16_f32 v211, v198, v199
    v_mfma_f32_16x16x32_bf16 v[180:183], a[104:107], a[8:11], v[180:183]
    ds_read_b128 a[128:131], v234 offset:2048
    ds_read_b128 a[132:135], v235 offset:2048
    v_mfma_f32_16x16x32_bf16 v[180:183], a[108:111], a[12:15], v[180:183]
    v_exp_f32_e64 v176, v176
    v_mfma_f32_16x16x32_bf16 v[144:147], a[176:179], v[208:211], v[144:147]
    ds_read_b128 a[136:139], v234 offset:6144
    ds_read_b128 a[140:143], v235 offset:6144
    v_mfma_f32_16x16x32_bf16 v[148:151], a[180:183], v[208:211], v[148:151]
    v_exp_f32_e64 v177, v177
    v_mfma_f32_16x16x32_bf16 v[152:155], a[184:187], v[208:211], v[152:155]
    ds_read_b64_tr_b16 a[176:177], v240 offset:16384
    v_cvt_pk_bf16_f32 v200, v176, v177
    v_mfma_f32_16x16x32_bf16 v[156:159], a[188:191], v[208:211], v[156:159]
    v_exp_f32_e64 v178, v178
    v_mfma_f32_16x16x32_bf16 v[160:163], a[192:195], v[208:211], v[160:163]
    ds_read_b64_tr_b16 a[178:179], v240 offset:18432
    ds_read_b64_tr_b16 a[180:181], v241 offset:16384
    v_mfma_f32_16x16x32_bf16 v[164:167], a[196:199], v[208:211], v[164:167]
    v_exp_f32_e64 v179, v179
    v_mfma_f32_16x16x32_bf16 v[168:171], a[200:203], v[208:211], v[168:171]
    ds_read_b64_tr_b16 a[182:183], v241 offset:18432
    v_cvt_pk_bf16_f32 v201, v178, v179
    v_mfma_f32_16x16x32_bf16 v[172:175], a[204:207], v[208:211], v[172:175]
    v_exp_f32_e64 v180, v180
    v_mfma_f32_16x16x32_bf16 a[224:227], a[228:231], v[208:211], a[224:227]
    ds_read_b64_tr_b16 a[184:185], v242 offset:16384
    ds_read_b64_tr_b16 a[186:187], v242 offset:18432
    v_mfma_f32_16x16x32_bf16 v[184:187], a[80:83], a[16:19], v[216:219]
    v_exp_f32_e64 v181, v181
    v_mfma_f32_16x16x32_bf16 v[184:187], a[84:87], a[20:23], v[184:187]
    ds_read_b64_tr_b16 a[188:189], v243 offset:16384
    v_cvt_pk_bf16_f32 v202, v180, v181
    v_mfma_f32_16x16x32_bf16 v[184:187], a[88:91], a[24:27], v[184:187]
    v_exp_f32_e64 v182, v182
    v_mfma_f32_16x16x32_bf16 v[184:187], a[92:95], a[28:31], v[184:187]
    ds_read_b64_tr_b16 a[190:191], v243 offset:18432
    ds_read_b64_tr_b16 a[192:193], v240 offset:20480
    v_mfma_f32_16x16x32_bf16 v[188:191], a[96:99], a[16:19], v[216:219]
    v_exp_f32_e64 v183, v183
    v_mfma_f32_16x16x32_bf16 v[188:191], a[100:103], a[20:23], v[188:191]
    ds_read_b64_tr_b16 a[194:195], v240 offset:22528
    v_cvt_pk_bf16_f32 v203, v182, v183
    v_mfma_f32_16x16x32_bf16 v[188:191], a[104:107], a[24:27], v[188:191]
    ds_read_b64_tr_b16 a[196:197], v241 offset:20480
    ds_read_b64_tr_b16 a[198:199], v241 offset:22528
    v_mfma_f32_16x16x32_bf16 v[188:191], a[108:111], a[28:31], v[188:191]
    v_exp_f32_e64 v184, v184
    v_mfma_f32_16x16x32_bf16 v[16:19], a[144:147], v[200:203], v[16:19]
    ds_read_b64_tr_b16 a[200:201], v242 offset:20480
    ds_read_b64_tr_b16 a[202:203], v242 offset:22528
    v_mfma_f32_16x16x32_bf16 v[20:23], a[148:151], v[200:203], v[20:23]
    v_exp_f32_e64 v185, v185
    v_mfma_f32_16x16x32_bf16 v[24:27], a[152:155], v[200:203], v[24:27]
    ds_read_b64_tr_b16 a[204:205], v243 offset:20480
    v_cvt_pk_bf16_f32 v204, v184, v185
    v_mfma_f32_16x16x32_bf16 v[28:31], a[156:159], v[200:203], v[28:31]
    v_exp_f32_e64 v186, v186
    v_mfma_f32_16x16x32_bf16 v[32:35], a[160:163], v[200:203], v[32:35]
    ds_read_b64_tr_b16 a[206:207], v243 offset:22528
    v_mfma_f32_16x16x32_bf16 v[36:39], a[164:167], v[200:203], v[36:39]
    v_exp_f32_e64 v187, v187
    v_mfma_f32_16x16x32_bf16 v[40:43], a[168:171], v[200:203], v[40:43]
    v_cvt_pk_bf16_f32 v205, v186, v187
    v_mfma_f32_16x16x32_bf16 v[44:47], a[172:175], v[200:203], v[44:47]
    v_exp_f32_e64 v188, v188
    v_mfma_f32_16x16x32_bf16 a[208:211], a[228:231], v[200:203], a[208:211]
    v_mfma_f32_16x16x32_bf16 v[192:195], a[80:83], a[32:35], v[220:223]
    v_exp_f32_e64 v189, v189
    v_mfma_f32_16x16x32_bf16 v[192:195], a[84:87], a[36:39], v[192:195]
    v_cvt_pk_bf16_f32 v206, v188, v189
    v_mfma_f32_16x16x32_bf16 v[192:195], a[88:91], a[40:43], v[192:195]
    v_exp_f32_e64 v190, v190
    v_mfma_f32_16x16x32_bf16 v[192:195], a[92:95], a[44:47], v[192:195]
    s_nop 0
    v_mfma_f32_16x16x32_bf16 v[196:199], a[96:99], a[32:35], v[220:223]
    s_nop 0
    v_exp_f32_e64 v191, v191
    v_mfma_f32_16x16x32_bf16 v[196:199], a[100:103], a[36:39], v[196:199]
    v_cvt_pk_bf16_f32 v207, v190, v191
    v_mfma_f32_16x16x32_bf16 v[196:199], a[104:107], a[40:43], v[196:199]
    v_mfma_f32_16x16x32_bf16 v[196:199], a[108:111], a[44:47], v[196:199]
    v_exp_f32_e64 v192, v192
    v_mfma_f32_16x16x32_bf16 v[48:51], a[144:147], v[204:207], v[48:51]
    v_mfma_f32_16x16x32_bf16 v[52:55], a[148:151], v[204:207], v[52:55]
    v_exp_f32_e64 v193, v193
    v_mfma_f32_16x16x32_bf16 v[56:59], a[152:155], v[204:207], v[56:59]
    v_cvt_pk_bf16_f32 v208, v192, v193
    v_mfma_f32_16x16x32_bf16 v[60:63], a[156:159], v[204:207], v[60:63]
    v_exp_f32_e64 v194, v194
    v_mfma_f32_16x16x32_bf16 v[64:67], a[160:163], v[204:207], v[64:67]
    v_mfma_f32_16x16x32_bf16 v[68:71], a[164:167], v[204:207], v[68:71]
    v_exp_f32_e64 v195, v195
    v_mfma_f32_16x16x32_bf16 v[72:75], a[168:171], v[204:207], v[72:75]
    v_cvt_pk_bf16_f32 v209, v194, v195
    v_mfma_f32_16x16x32_bf16 v[76:79], a[172:175], v[204:207], v[76:79]
    v_exp_f32_e64 v196, v196
    v_mfma_f32_16x16x32_bf16 a[212:215], a[228:231], v[204:207], a[212:215]
    v_mfma_f32_16x16x32_bf16 v[176:179], a[80:83], a[48:51], v[224:227]
    v_exp_f32_e64 v197, v197
    v_mfma_f32_16x16x32_bf16 v[176:179], a[84:87], a[52:55], v[176:179]
    v_cvt_pk_bf16_f32 v210, v196, v197
    v_mfma_f32_16x16x32_bf16 v[176:179], a[88:91], a[56:59], v[176:179]
    v_exp_f32_e64 v198, v198
    v_mfma_f32_16x16x32_bf16 v[176:179], a[92:95], a[60:63], v[176:179]
    s_nop 0
    v_mfma_f32_16x16x32_bf16 v[180:183], a[96:99], a[48:51], v[224:227]
    s_nop 0
    v_exp_f32_e64 v199, v199
    v_mfma_f32_16x16x32_bf16 v[180:183], a[100:103], a[52:55], v[180:183]
    v_cvt_pk_bf16_f32 v211, v198, v199
    v_mfma_f32_16x16x32_bf16 v[180:183], a[104:107], a[56:59], v[180:183]
    v_mfma_f32_16x16x32_bf16 v[180:183], a[108:111], a[60:63], v[180:183]
    v_exp_f32_e64 v176, v176
    v_mfma_f32_16x16x32_bf16 v[80:83], a[144:147], v[208:211], v[80:83]
    v_mfma_f32_16x16x32_bf16 v[84:87], a[148:151], v[208:211], v[84:87]
    v_exp_f32_e64 v177, v177
    v_mfma_f32_16x16x32_bf16 v[88:91], a[152:155], v[208:211], v[88:91]
    v_cvt_pk_bf16_f32 v200, v176, v177
    v_mfma_f32_16x16x32_bf16 v[92:95], a[156:159], v[208:211], v[92:95]
    v_exp_f32_e64 v178, v178
    v_mfma_f32_16x16x32_bf16 v[96:99], a[160:163], v[208:211], v[96:99]
    s_waitcnt vmcnt(0)
    v_mfma_f32_16x16x32_bf16 v[100:103], a[164:167], v[208:211], v[100:103]
    s_waitcnt lgkmcnt(0)
    v_exp_f32_e64 v179, v179
    v_mfma_f32_16x16x32_bf16 v[104:107], a[168:171], v[208:211], v[104:107]
    s_barrier
    v_cvt_pk_bf16_f32 v201, v178, v179
    v_mfma_f32_16x16x32_bf16 v[108:111], a[172:175], v[208:211], v[108:111]
    s_mov_b32 m0, s27
    v_exp_f32_e64 v180, v180
    v_mfma_f32_16x16x32_bf16 a[216:219], a[228:231], v[208:211], a[216:219]
    ds_read_b128 a[80:83], v232 offset:32768
    ds_read_b128 a[84:87], v233 offset:32768
    v_mfma_f32_16x16x32_bf16 v[184:187], a[112:115], a[0:3], v[212:215]
    v_exp_f32_e64 v181, v181
    v_mfma_f32_16x16x32_bf16 v[184:187], a[116:119], a[4:7], v[184:187]
    ds_read_b128 a[88:91], v232 offset:36864
    v_cvt_pk_bf16_f32 v202, v180, v181
    v_mfma_f32_16x16x32_bf16 v[184:187], a[120:123], a[8:11], v[184:187]
    v_exp_f32_e64 v182, v182
    v_mfma_f32_16x16x32_bf16 v[184:187], a[124:127], a[12:15], v[184:187]
    buffer_load_dwordx4 v244, s[8:11], s26 offen offset:0 nt lds
    v_mfma_f32_16x16x32_bf16 v[188:191], a[128:131], a[0:3], v[212:215]
    v_exp_f32_e64 v183, v183
    v_mfma_f32_16x16x32_bf16 v[188:191], a[132:135], a[4:7], v[188:191]
    ds_read_b128 a[92:95], v233 offset:36864
    v_cvt_pk_bf16_f32 v203, v182, v183
    v_mfma_f32_16x16x32_bf16 v[188:191], a[136:139], a[8:11], v[188:191]
    ds_read_b128 a[96:99], v232 offset:34816
    ds_read_b128 a[100:103], v233 offset:34816
    v_mfma_f32_16x16x32_bf16 v[188:191], a[140:143], a[12:15], v[188:191]
    v_exp_f32_e64 v184, v184
    v_mfma_f32_16x16x32_bf16 v[112:115], a[144:147], v[200:203], v[112:115]
    ds_read_b128 a[104:107], v232 offset:38912
    ds_read_b128 a[108:111], v233 offset:38912
    v_mfma_f32_16x16x32_bf16 v[116:119], a[148:151], v[200:203], v[116:119]
    v_exp_f32_e64 v185, v185
    v_mfma_f32_16x16x32_bf16 v[120:123], a[152:155], v[200:203], v[120:123]
    ds_read_b64_tr_b16 a[144:145], v236 offset:49152
    v_cvt_pk_bf16_f32 v204, v184, v185
    v_mfma_f32_16x16x32_bf16 v[124:127], a[156:159], v[200:203], v[124:127]
    v_exp_f32_e64 v186, v186
    v_mfma_f32_16x16x32_bf16 v[128:131], a[160:163], v[200:203], v[128:131]
    buffer_load_dwordx4 v245, s[8:11], s26 offen offset:1024 nt lds
    v_mfma_f32_16x16x32_bf16 v[132:135], a[164:167], v[200:203], v[132:135]
    v_exp_f32_e64 v187, v187
    v_mfma_f32_16x16x32_bf16 v[136:139], a[168:171], v[200:203], v[136:139]
    ds_read_b64_tr_b16 a[146:147], v236 offset:51200
    v_cvt_pk_bf16_f32 v205, v186, v187
    v_mfma_f32_16x16x32_bf16 v[140:143], a[172:175], v[200:203], v[140:143]
    v_exp_f32_e64 v188, v188
    v_mfma_f32_16x16x32_bf16 a[220:223], a[228:231], v[200:203], a[220:223]
    ds_read_b64_tr_b16 a[148:149], v237 offset:49152
    ds_read_b64_tr_b16 a[150:151], v237 offset:51200
    v_mfma_f32_16x16x32_bf16 v[192:195], a[112:115], a[16:19], v[216:219]
    v_exp_f32_e64 v189, v189
    v_mfma_f32_16x16x32_bf16 v[192:195], a[116:119], a[20:23], v[192:195]
    ds_read_b64_tr_b16 a[152:153], v238 offset:49152
    v_cvt_pk_bf16_f32 v206, v188, v189
    v_mfma_f32_16x16x32_bf16 v[192:195], a[120:123], a[24:27], v[192:195]
    v_exp_f32_e64 v190, v190
    v_mfma_f32_16x16x32_bf16 v[192:195], a[124:127], a[28:31], v[192:195]
    buffer_load_dwordx4 v246, s[8:11], s26 offen offset:2048 nt lds
    v_mfma_f32_16x16x32_bf16 v[196:199], a[128:131], a[16:19], v[216:219]
    v_exp_f32_e64 v191, v191
    v_mfma_f32_16x16x32_bf16 v[196:199], a[132:135], a[20:23], v[196:199]
    ds_read_b64_tr_b16 a[154:155], v238 offset:51200
    v_cvt_pk_bf16_f32 v207, v190, v191
    v_mfma_f32_16x16x32_bf16 v[196:199], a[136:139], a[24:27], v[196:199]
    ds_read_b64_tr_b16 a[156:157], v239 offset:49152
    ds_read_b64_tr_b16 a[158:159], v239 offset:51200
    v_mfma_f32_16x16x32_bf16 v[196:199], a[140:143], a[28:31], v[196:199]
    v_exp_f32_e64 v192, v192
    v_mfma_f32_16x16x32_bf16 v[16:19], a[176:179], v[204:207], v[16:19]
    ds_read_b64_tr_b16 a[160:161], v236 offset:53248
    ds_read_b64_tr_b16 a[162:163], v236 offset:55296
    v_mfma_f32_16x16x32_bf16 v[20:23], a[180:183], v[204:207], v[20:23]
    v_exp_f32_e64 v193, v193
    v_mfma_f32_16x16x32_bf16 v[24:27], a[184:187], v[204:207], v[24:27]
    ds_read_b64_tr_b16 a[164:165], v237 offset:53248
    v_cvt_pk_bf16_f32 v208, v192, v193
    v_mfma_f32_16x16x32_bf16 v[28:31], a[188:191], v[204:207], v[28:31]
    v_exp_f32_e64 v194, v194
    v_mfma_f32_16x16x32_bf16 v[32:35], a[192:195], v[204:207], v[32:35]
    buffer_load_dwordx4 v247, s[8:11], s26 offen offset:3072 nt lds
    v_mfma_f32_16x16x32_bf16 v[36:39], a[196:199], v[204:207], v[36:39]
    s_add_u32 m0, s27, 16384
    v_exp_f32_e64 v195, v195
    v_mfma_f32_16x16x32_bf16 v[40:43], a[200:203], v[204:207], v[40:43]
    ds_read_b64_tr_b16 a[166:167], v237 offset:55296
    v_cvt_pk_bf16_f32 v209, v194, v195
    v_mfma_f32_16x16x32_bf16 v[44:47], a[204:207], v[204:207], v[44:47]
    v_exp_f32_e64 v196, v196
    v_mfma_f32_16x16x32_bf16 a[208:211], a[228:231], v[204:207], a[208:211]
    ds_read_b64_tr_b16 a[168:169], v238 offset:53248
    ds_read_b64_tr_b16 a[170:171], v238 offset:55296
    v_mfma_f32_16x16x32_bf16 v[176:179], a[112:115], a[32:35], v[220:223]
    v_exp_f32_e64 v197, v197
    v_mfma_f32_16x16x32_bf16 v[176:179], a[116:119], a[36:39], v[176:179]
    ds_read_b64_tr_b16 a[172:173], v239 offset:53248
    v_cvt_pk_bf16_f32 v210, v196, v197
    v_mfma_f32_16x16x32_bf16 v[176:179], a[120:123], a[40:43], v[176:179]
    v_exp_f32_e64 v198, v198
    v_mfma_f32_16x16x32_bf16 v[176:179], a[124:127], a[44:47], v[176:179]
    buffer_load_dwordx4 v248, s[12:15], s26 offen offset:0 nt lds
    v_mfma_f32_16x16x32_bf16 v[180:183], a[128:131], a[32:35], v[220:223]
    v_exp_f32_e64 v199, v199
    v_mfma_f32_16x16x32_bf16 v[180:183], a[132:135], a[36:39], v[180:183]
    ds_read_b64_tr_b16 a[174:175], v239 offset:55296
    v_cvt_pk_bf16_f32 v211, v198, v199
    v_mfma_f32_16x16x32_bf16 v[180:183], a[136:139], a[40:43], v[180:183]
    v_mfma_f32_16x16x32_bf16 v[180:183], a[140:143], a[44:47], v[180:183]
    v_exp_f32_e64 v176, v176
    v_mfma_f32_16x16x32_bf16 v[48:51], a[176:179], v[208:211], v[48:51]
    v_mfma_f32_16x16x32_bf16 v[52:55], a[180:183], v[208:211], v[52:55]
    v_exp_f32_e64 v177, v177
    v_mfma_f32_16x16x32_bf16 v[56:59], a[184:187], v[208:211], v[56:59]
    v_cvt_pk_bf16_f32 v200, v176, v177
    v_mfma_f32_16x16x32_bf16 v[60:63], a[188:191], v[208:211], v[60:63]
    v_exp_f32_e64 v178, v178
    v_mfma_f32_16x16x32_bf16 v[64:67], a[192:195], v[208:211], v[64:67]
    buffer_load_dwordx4 v249, s[12:15], s26 offen offset:1024 nt lds
    v_mfma_f32_16x16x32_bf16 v[68:71], a[196:199], v[208:211], v[68:71]
    v_exp_f32_e64 v179, v179
    v_mfma_f32_16x16x32_bf16 v[72:75], a[200:203], v[208:211], v[72:75]
    v_cvt_pk_bf16_f32 v201, v178, v179
    v_mfma_f32_16x16x32_bf16 v[76:79], a[204:207], v[208:211], v[76:79]
    v_exp_f32_e64 v180, v180
    v_mfma_f32_16x16x32_bf16 a[212:215], a[228:231], v[208:211], a[212:215]
    v_mfma_f32_16x16x32_bf16 v[184:187], a[112:115], a[48:51], v[224:227]
    v_exp_f32_e64 v181, v181
    v_mfma_f32_16x16x32_bf16 v[184:187], a[116:119], a[52:55], v[184:187]
    v_cvt_pk_bf16_f32 v202, v180, v181
    v_mfma_f32_16x16x32_bf16 v[184:187], a[120:123], a[56:59], v[184:187]
    v_exp_f32_e64 v182, v182
    v_mfma_f32_16x16x32_bf16 v[184:187], a[124:127], a[60:63], v[184:187]
    buffer_load_dwordx4 v250, s[12:15], s26 offen offset:2048 nt lds
    v_mfma_f32_16x16x32_bf16 v[188:191], a[128:131], a[48:51], v[224:227]
    s_nop 0
    v_exp_f32 v183, v183
    v_mfma_f32_16x16x32_bf16 v[188:191], a[132:135], a[52:55], v[188:191]
    v_cvt_pk_bf16_f32 v203, v182, v183
    v_mfma_f32_16x16x32_bf16 v[188:191], a[136:139], a[56:59], v[188:191]
    v_mfma_f32_16x16x32_bf16 v[188:191], a[140:143], a[60:63], v[188:191]
    v_exp_f32_e64 v184, v184
    v_mfma_f32_16x16x32_bf16 v[80:83], a[176:179], v[200:203], v[80:83]
    v_mfma_f32_16x16x32_bf16 v[84:87], a[180:183], v[200:203], v[84:87]
    v_exp_f32_e64 v185, v185
    v_mfma_f32_16x16x32_bf16 v[88:91], a[184:187], v[200:203], v[88:91]
    v_cvt_pk_bf16_f32 v204, v184, v185
    v_mfma_f32_16x16x32_bf16 v[92:95], a[188:191], v[200:203], v[92:95]
    v_exp_f32_e64 v186, v186
    v_mfma_f32_16x16x32_bf16 v[96:99], a[192:195], v[200:203], v[96:99]
    buffer_load_dwordx4 v251, s[12:15], s26 offen offset:3072 nt lds
    v_mfma_f32_16x16x32_bf16 v[100:103], a[196:199], v[200:203], v[100:103]
    s_add_u32 s26, s26, 16384
    v_exp_f32_e64 v187, v187
    v_mfma_f32_16x16x32_bf16 v[104:107], a[200:203], v[200:203], v[104:107]
    s_and_b32 s26, s26, 0x7ffff
    v_cvt_pk_bf16_f32 v205, v186, v187
    v_mfma_f32_16x16x32_bf16 v[108:111], a[204:207], v[200:203], v[108:111]
    s_sub_u32 s28, s28, 1
    v_exp_f32 v188, v188
    v_mfma_f32_16x16x32_bf16 a[216:219], a[228:231], v[200:203], a[216:219]
    s_cselect_b32 s10, 0, s10
    v_mfma_f32_16x16x32_bf16 v[192:195], a[112:115], a[64:67], v[228:231]
    s_cselect_b32 s14, 0, s14
    v_exp_f32_e64 v189, v189
    v_mfma_f32_16x16x32_bf16 v[192:195], a[116:119], a[68:71], v[192:195]
    v_cvt_pk_bf16_f32 v206, v188, v189
    v_mfma_f32_16x16x32_bf16 v[192:195], a[120:123], a[72:75], v[192:195]
    v_exp_f32_e64 v190, v190
    v_mfma_f32_16x16x32_bf16 v[192:195], a[124:127], a[76:79], v[192:195]
    s_nop 0
    v_mfma_f32_16x16x32_bf16 v[196:199], a[128:131], a[64:67], v[228:231]
    s_nop 0
    v_exp_f32_e64 v191, v191
    v_mfma_f32_16x16x32_bf16 v[196:199], a[132:135], a[68:71], v[196:199]
    v_cvt_pk_bf16_f32 v207, v190, v191
    v_mfma_f32_16x16x32_bf16 v[196:199], a[136:139], a[72:75], v[196:199]
    v_mfma_f32_16x16x32_bf16 v[196:199], a[140:143], a[76:79], v[196:199]
    v_exp_f32_e64 v192, v192
    v_mfma_f32_16x16x32_bf16 v[112:115], a[176:179], v[204:207], v[112:115]
    v_mfma_f32_16x16x32_bf16 v[116:119], a[180:183], v[204:207], v[116:119]
    v_exp_f32_e64 v193, v193
    v_mfma_f32_16x16x32_bf16 v[120:123], a[184:187], v[204:207], v[120:123]
    v_cvt_pk_bf16_f32 v208, v192, v193
    v_mfma_f32_16x16x32_bf16 v[124:127], a[188:191], v[204:207], v[124:127]
    v_exp_f32_e64 v194, v194
    v_mfma_f32_16x16x32_bf16 v[128:131], a[192:195], v[204:207], v[128:131]
    v_mfma_f32_16x16x32_bf16 v[132:135], a[196:199], v[204:207], v[132:135]
    v_exp_f32_e64 v195, v195
    v_mfma_f32_16x16x32_bf16 v[136:139], a[200:203], v[204:207], v[136:139]
    s_sub_u32 s35, s35, 1
    v_cvt_pk_bf16_f32 v209, v194, v195
    v_mfma_f32_16x16x32_bf16 v[140:143], a[204:207], v[204:207], v[140:143]
    s_cmp_lg_u32 s35, 0
    v_exp_f32_e64 v196, v196
    v_mfma_f32_16x16x32_bf16 a[220:223], a[228:231], v[204:207], a[220:223]
    s_waitcnt lgkmcnt(0)
    s_cbranch_scc1 L_loop
    v_mfma_f32_16x16x32_bf16 v[176:179], a[80:83], a[0:3], v[212:215]
    v_exp_f32_e64 v197, v197
    v_mfma_f32_16x16x32_bf16 v[176:179], a[84:87], a[4:7], v[176:179]
    ds_read_b128 a[112:115], v234 offset:32768
    v_cvt_pk_bf16_f32 v210, v196, v197
    v_mfma_f32_16x16x32_bf16 v[176:179], a[88:91], a[8:11], v[176:179]
    v_exp_f32_e64 v198, v198
    v_mfma_f32_16x16x32_bf16 v[176:179], a[92:95], a[12:15], v[176:179]
    ds_read_b128 a[116:119], v235 offset:32768
    ds_read_b128 a[120:123], v234 offset:36864
    v_mfma_f32_16x16x32_bf16 v[180:183], a[96:99], a[0:3], v[212:215]
    v_exp_f32_e64 v199, v199
    v_mfma_f32_16x16x32_bf16 v[180:183], a[100:103], a[4:7], v[180:183]
    ds_read_b128 a[124:127], v235 offset:36864
    v_cvt_pk_bf16_f32 v211, v198, v199
    v_mfma_f32_16x16x32_bf16 v[180:183], a[104:107], a[8:11], v[180:183]
    ds_read_b128 a[128:131], v234 offset:34816
    ds_read_b128 a[132:135], v235 offset:34816
    v_mfma_f32_16x16x32_bf16 v[180:183], a[108:111], a[12:15], v[180:183]
    v_exp_f32_e64 v176, v176
    v_mfma_f32_16x16x32_bf16 v[144:147], a[176:179], v[208:211], v[144:147]
    ds_read_b128 a[136:139], v234 offset:38912
    ds_read_b128 a[140:143], v235 offset:38912
    v_mfma_f32_16x16x32_bf16 v[148:151], a[180:183], v[208:211], v[148:151]
    v_exp_f32_e64 v177, v177
    v_mfma_f32_16x16x32_bf16 v[152:155], a[184:187], v[208:211], v[152:155]
    ds_read_b64_tr_b16 a[176:177], v240 offset:49152
    v_cvt_pk_bf16_f32 v200, v176, v177
    v_mfma_f32_16x16x32_bf16 v[156:159], a[188:191], v[208:211], v[156:159]
    v_exp_f32_e64 v178, v178
    v_mfma_f32_16x16x32_bf16 v[160:163], a[192:195], v[208:211], v[160:163]
    ds_read_b64_tr_b16 a[178:179], v240 offset:51200
    ds_read_b64_tr_b16 a[180:181], v241 offset:49152
    v_mfma_f32_16x16x32_bf16 v[164:167], a[196:199], v[208:211], v[164:167]
    v_exp_f32_e64 v179, v179
    v_mfma_f32_16x16x32_bf16 v[168:171], a[200:203], v[208:211], v[168:171]
    ds_read_b64_tr_b16 a[182:183], v241 offset:51200
    v_cvt_pk_bf16_f32 v201, v178, v179
    v_mfma_f32_16x16x32_bf16 v[172:175], a[204:207], v[208:211], v[172:175]
    s_waitcnt lgkmcnt(4)
    v_exp_f32 v180, v180
    v_mfma_f32_16x16x32_bf16 a[224:227], a[228:231], v[208:211], a[224:227]
    ds_read_b64_tr_b16 a[184:185], v242 offset:49152
    ds_read_b64_tr_b16 a[186:187], v242 offset:51200
    v_mfma_f32_16x16x32_bf16 v[184:187], a[112:115], a[0:3], v[212:215]
    v_exp_f32_e64 v181, v181
    v_mfma_f32_16x16x32_bf16 v[184:187], a[116:119], a[4:7], v[184:187]
    ds_read_b64_tr_b16 a[188:189], v243 offset:49152
    v_cvt_pk_bf16_f32 v202, v180, v181
    v_mfma_f32_16x16x32_bf16 v[184:187], a[120:123], a[8:11], v[184:187]
    v_exp_f32_e64 v182, v182
    v_mfma_f32_16x16x32_bf16 v[184:187], a[124:127], a[12:15], v[184:187]
    ds_read_b64_tr_b16 a[190:191], v243 offset:51200
    ds_read_b64_tr_b16 a[192:193], v240 offset:53248
    v_mfma_f32_16x16x32_bf16 v[188:191], a[128:131], a[0:3], v[212:215]
    v_exp_f32_e64 v183, v183
    v_mfma_f32_16x16x32_bf16 v[188:191], a[132:135], a[4:7], v[188:191]
    ds_read_b64_tr_b16 a[194:195], v240 offset:55296
    v_cvt_pk_bf16_f32 v203, v182, v183
    v_mfma_f32_16x16x32_bf16 v[188:191], a[136:139], a[8:11], v[188:191]
    ds_read_b64_tr_b16 a[196:197], v241 offset:53248
    ds_read_b64_tr_b16 a[198:199], v241 offset:55296
    v_mfma_f32_16x16x32_bf16 v[188:191], a[140:143], a[12:15], v[188:191]
    v_exp_f32_e64 v184, v184
    v_mfma_f32_16x16x32_bf16 v[16:19], a[144:147], v[200:203], v[16:19]
    ds_read_b64_tr_b16 a[200:201], v242 offset:53248
    ds_read_b64_tr_b16 a[202:203], v242 offset:55296
    v_mfma_f32_16x16x32_bf16 v[20:23], a[148:151], v[200:203], v[20:23]
    v_exp_f32_e64 v185, v185
    v_mfma_f32_16x16x32_bf16 v[24:27], a[152:155], v[200:203], v[24:27]
    ds_read_b64_tr_b16 a[204:205], v243 offset:53248
    v_cvt_pk_bf16_f32 v204, v184, v185
    v_mfma_f32_16x16x32_bf16 v[28:31], a[156:159], v[200:203], v[28:31]
    v_exp_f32_e64 v186, v186
    v_mfma_f32_16x16x32_bf16 v[32:35], a[160:163], v[200:203], v[32:35]
    ds_read_b64_tr_b16 a[206:207], v243 offset:55296
    v_mfma_f32_16x16x32_bf16 v[36:39], a[164:167], v[200:203], v[36:39]
    v_exp_f32_e64 v187, v187
    v_mfma_f32_16x16x32_bf16 v[40:43], a[168:171], v[200:203], v[40:43]
    v_cvt_pk_bf16_f32 v205, v186, v187
    v_mfma_f32_16x16x32_bf16 v[44:47], a[172:175], v[200:203], v[44:47]
    v_exp_f32_e64 v188, v188
    v_mfma_f32_16x16x32_bf16 a[208:211], a[228:231], v[200:203], a[208:211]
    s_nop 0
    v_mfma_f32_16x16x32_bf16 v[192:195], a[80:83], a[16:19], v[216:219]
    v_exp_f32 v189, v189
    v_mfma_f32_16x16x32_bf16 v[192:195], a[84:87], a[20:23], v[192:195]
    v_cvt_pk_bf16_f32 v206, v188, v189
    v_mfma_f32_16x16x32_bf16 v[192:195], a[88:91], a[24:27], v[192:195]
    v_exp_f32_e64 v190, v190
    v_mfma_f32_16x16x32_bf16 v[192:195], a[92:95], a[28:31], v[192:195]
    s_nop 0
    v_mfma_f32_16x16x32_bf16 v[196:199], a[96:99], a[16:19], v[216:219]
    v_exp_f32 v191, v191
    v_mfma_f32_16x16x32_bf16 v[196:199], a[100:103], a[20:23], v[196:199]
    v_cvt_pk_bf16_f32 v207, v190, v191
    v_mfma_f32_16x16x32_bf16 v[196:199], a[104:107], a[24:27], v[196:199]
    v_mfma_f32_16x16x32_bf16 v[196:199], a[108:111], a[28:31], v[196:199]
    s_waitcnt lgkmcnt(0)
    v_exp_f32 v192, v192
    v_mfma_f32_16x16x32_bf16 v[16:19], a[176:179], v[204:207], v[16:19]
    v_mfma_f32_16x16x32_bf16 v[20:23], a[180:183], v[204:207], v[20:23]
    v_exp_f32_e64 v193, v193
    v_mfma_f32_16x16x32_bf16 v[24:27], a[184:187], v[204:207], v[24:27]
    v_cvt_pk_bf16_f32 v208, v192, v193
    v_mfma_f32_16x16x32_bf16 v[28:31], a[188:191], v[204:207], v[28:31]
    v_exp_f32_e64 v194, v194
    v_mfma_f32_16x16x32_bf16 v[32:35], a[192:195], v[204:207], v[32:35]
    v_mfma_f32_16x16x32_bf16 v[36:39], a[196:199], v[204:207], v[36:39]
    v_exp_f32_e64 v195, v195
    v_mfma_f32_16x16x32_bf16 v[40:43], a[200:203], v[204:207], v[40:43]
    v_cvt_pk_bf16_f32 v209, v194, v195
    v_mfma_f32_16x16x32_bf16 v[44:47], a[204:207], v[204:207], v[44:47]
    v_exp_f32_e64 v196, v196
    v_mfma_f32_16x16x32_bf16 a[208:211], a[228:231], v[204:207], a[208:211]
    s_nop 0
    v_mfma_f32_16x16x32_bf16 v[176:179], a[112:115], a[16:19], v[216:219]
    v_exp_f32 v197, v197
    v_mfma_f32_16x16x32_bf16 v[176:179], a[116:119], a[20:23], v[176:179]
    v_cvt_pk_bf16_f32 v210, v196, v197
    v_mfma_f32_16x16x32_bf16 v[176:179], a[120:123], a[24:27], v[176:179]
    v_exp_f32_e64 v198, v198
    v_mfma_f32_16x16x32_bf16 v[176:179], a[124:127], a[28:31], v[176:179]
    v_accvgpr_read_b32 v6, a208
    s_lshl_b32 s34, s24, 14
    v_mov_b32 v1, v6
    v_rcp_f32 v6, v6
    s_add_u32 s34, s34, 0
    v_pk_mul_f32 v[16:17], v[16:17], v[6:7] op_sel_hi:[1,0]
    v_pk_mul_f32 v[18:19], v[18:19], v[6:7] op_sel_hi:[1,0]
    v_pk_mul_f32 v[20:21], v[20:21], v[6:7] op_sel_hi:[1,0]
    v_pk_mul_f32 v[22:23], v[22:23], v[6:7] op_sel_hi:[1,0]
    v_pk_mul_f32 v[24:25], v[24:25], v[6:7] op_sel_hi:[1,0]
    v_pk_mul_f32 v[26:27], v[26:27], v[6:7] op_sel_hi:[1,0]
    v_pk_mul_f32 v[28:29], v[28:29], v[6:7] op_sel_hi:[1,0]
    v_pk_mul_f32 v[30:31], v[30:31], v[6:7] op_sel_hi:[1,0]
    v_pk_mul_f32 v[32:33], v[32:33], v[6:7] op_sel_hi:[1,0]
    v_pk_mul_f32 v[34:35], v[34:35], v[6:7] op_sel_hi:[1,0]
    v_pk_mul_f32 v[36:37], v[36:37], v[6:7] op_sel_hi:[1,0]
    v_pk_mul_f32 v[38:39], v[38:39], v[6:7] op_sel_hi:[1,0]
    v_pk_mul_f32 v[40:41], v[40:41], v[6:7] op_sel_hi:[1,0]
    v_pk_mul_f32 v[42:43], v[42:43], v[6:7] op_sel_hi:[1,0]
    v_pk_mul_f32 v[44:45], v[44:45], v[6:7] op_sel_hi:[1,0]
    v_pk_mul_f32 v[46:47], v[46:47], v[6:7] op_sel_hi:[1,0]
    v_cvt_pk_bf16_f32 v16, v16, v17
    v_cvt_pk_bf16_f32 v17, v18, v19
    v_cvt_pk_bf16_f32 v18, v20, v21
    v_cvt_pk_bf16_f32 v19, v22, v23
    v_cvt_pk_bf16_f32 v20, v24, v25
    v_cvt_pk_bf16_f32 v21, v26, v27
    v_cvt_pk_bf16_f32 v22, v28, v29
    v_cvt_pk_bf16_f32 v23, v30, v31
    v_cvt_pk_bf16_f32 v24, v32, v33
    v_cvt_pk_bf16_f32 v25, v34, v35
    v_cvt_pk_bf16_f32 v26, v36, v37
    v_cvt_pk_bf16_f32 v27, v38, v39
    v_cvt_pk_bf16_f32 v28, v40, v41
    v_cvt_pk_bf16_f32 v29, v42, v43
    v_cvt_pk_bf16_f32 v30, v44, v45
    v_cvt_pk_bf16_f32 v31, v46, v47
    v_permlane16_swap_b32 v16, v18
    v_permlane16_swap_b32 v17, v19
    buffer_store_dwordx4 v[16:19], v5, s[20:23], s34 offen offset:0
    v_permlane16_swap_b32 v20, v22
    v_permlane16_swap_b32 v21, v23
    buffer_store_dwordx4 v[20:23], v5, s[20:23], s34 offen offset:64
    v_permlane16_swap_b32 v24, v26
    v_permlane16_swap_b32 v25, v27
    buffer_store_dwordx4 v[24:27], v5, s[20:23], s34 offen offset:128
    v_permlane16_swap_b32 v28, v30
    v_permlane16_swap_b32 v29, v31
    buffer_store_dwordx4 v[28:31], v5, s[20:23], s34 offen offset:192
    v_mfma_f32_16x16x32_bf16 v[180:183], a[128:131], a[16:19], v[216:219]
    v_exp_f32 v199, v199
    v_mfma_f32_16x16x32_bf16 v[180:183], a[132:135], a[20:23], v[180:183]
    v_cvt_pk_bf16_f32 v211, v198, v199
    v_mfma_f32_16x16x32_bf16 v[180:183], a[136:139], a[24:27], v[180:183]
    v_mfma_f32_16x16x32_bf16 v[180:183], a[140:143], a[28:31], v[180:183]
    v_exp_f32_e64 v176, v176
    v_mfma_f32_16x16x32_bf16 v[48:51], a[144:147], v[208:211], v[48:51]
    v_mfma_f32_16x16x32_bf16 v[52:55], a[148:151], v[208:211], v[52:55]
    v_exp_f32_e64 v177, v177
    v_mfma_f32_16x16x32_bf16 v[56:59], a[152:155], v[208:211], v[56:59]
    v_cvt_pk_bf16_f32 v200, v176, v177
    v_mfma_f32_16x16x32_bf16 v[60:63], a[156:159], v[208:211], v[60:63]
    v_exp_f32_e64 v178, v178
    v_mfma_f32_16x16x32_bf16 v[64:67], a[160:163], v[208:211], v[64:67]
    v_mfma_f32_16x16x32_bf16 v[68:71], a[164:167], v[208:211], v[68:71]
    v_exp_f32_e64 v179, v179
    v_mfma_f32_16x16x32_bf16 v[72:75], a[168:171], v[208:211], v[72:75]
    v_cvt_pk_bf16_f32 v201, v178, v179
    v_mfma_f32_16x16x32_bf16 v[76:79], a[172:175], v[208:211], v[76:79]
    v_exp_f32_e64 v180, v180
    v_mfma_f32_16x16x32_bf16 a[212:215], a[228:231], v[208:211], a[212:215]
    s_nop 0
    v_mfma_f32_16x16x32_bf16 v[184:187], a[80:83], a[32:35], v[220:223]
    v_exp_f32 v181, v181
    v_mfma_f32_16x16x32_bf16 v[184:187], a[84:87], a[36:39], v[184:187]
    v_cvt_pk_bf16_f32 v202, v180, v181
    v_mfma_f32_16x16x32_bf16 v[184:187], a[88:91], a[40:43], v[184:187]
    v_exp_f32_e64 v182, v182
    v_mfma_f32_16x16x32_bf16 v[184:187], a[92:95], a[44:47], v[184:187]
    s_nop 0
    v_mfma_f32_16x16x32_bf16 v[188:191], a[96:99], a[32:35], v[220:223]
    s_nop 0
    v_exp_f32_e64 v183, v183
    v_mfma_f32_16x16x32_bf16 v[188:191], a[100:103], a[36:39], v[188:191]
    v_cvt_pk_bf16_f32 v203, v182, v183
    v_mfma_f32_16x16x32_bf16 v[188:191], a[104:107], a[40:43], v[188:191]
    v_mfma_f32_16x16x32_bf16 v[188:191], a[108:111], a[44:47], v[188:191]
    v_exp_f32_e64 v184, v184
    v_mfma_f32_16x16x32_bf16 v[48:51], a[176:179], v[200:203], v[48:51]
    v_mfma_f32_16x16x32_bf16 v[52:55], a[180:183], v[200:203], v[52:55]
    v_exp_f32_e64 v185, v185
    v_mfma_f32_16x16x32_bf16 v[56:59], a[184:187], v[200:203], v[56:59]
    v_cvt_pk_bf16_f32 v204, v184, v185
    v_mfma_f32_16x16x32_bf16 v[60:63], a[188:191], v[200:203], v[60:63]
    v_exp_f32_e64 v186, v186
    v_mfma_f32_16x16x32_bf16 v[64:67], a[192:195], v[200:203], v[64:67]
    v_mfma_f32_16x16x32_bf16 v[68:71], a[196:199], v[200:203], v[68:71]
    v_exp_f32_e64 v187, v187
    v_mfma_f32_16x16x32_bf16 v[72:75], a[200:203], v[200:203], v[72:75]
    v_cvt_pk_bf16_f32 v205, v186, v187
    v_mfma_f32_16x16x32_bf16 v[76:79], a[204:207], v[200:203], v[76:79]
    v_exp_f32_e64 v188, v188
    v_mfma_f32_16x16x32_bf16 a[212:215], a[228:231], v[200:203], a[212:215]
    s_nop 0
    v_mfma_f32_16x16x32_bf16 v[192:195], a[112:115], a[32:35], v[220:223]
    v_exp_f32 v189, v189
    v_mfma_f32_16x16x32_bf16 v[192:195], a[116:119], a[36:39], v[192:195]
    v_cvt_pk_bf16_f32 v206, v188, v189
    v_mfma_f32_16x16x32_bf16 v[192:195], a[120:123], a[40:43], v[192:195]
    v_exp_f32_e64 v190, v190
    v_mfma_f32_16x16x32_bf16 v[192:195], a[124:127], a[44:47], v[192:195]
    v_accvgpr_read_b32 v8, a212
    s_lshl_b32 s34, s24, 14
    v_add_f32 v1, v1, v8
    v_rcp_f32 v8, v8
    s_add_u32 s34, s34, 4096
    v_pk_mul_f32 v[48:49], v[48:49], v[8:9] op_sel_hi:[1,0]
    v_pk_mul_f32 v[50:51], v[50:51], v[8:9] op_sel_hi:[1,0]
    v_pk_mul_f32 v[52:53], v[52:53], v[8:9] op_sel_hi:[1,0]
    v_pk_mul_f32 v[54:55], v[54:55], v[8:9] op_sel_hi:[1,0]
    v_pk_mul_f32 v[56:57], v[56:57], v[8:9] op_sel_hi:[1,0]
    v_pk_mul_f32 v[58:59], v[58:59], v[8:9] op_sel_hi:[1,0]
    v_pk_mul_f32 v[60:61], v[60:61], v[8:9] op_sel_hi:[1,0]
    v_pk_mul_f32 v[62:63], v[62:63], v[8:9] op_sel_hi:[1,0]
    v_pk_mul_f32 v[64:65], v[64:65], v[8:9] op_sel_hi:[1,0]
    v_pk_mul_f32 v[66:67], v[66:67], v[8:9] op_sel_hi:[1,0]
    v_pk_mul_f32 v[68:69], v[68:69], v[8:9] op_sel_hi:[1,0]
    v_pk_mul_f32 v[70:71], v[70:71], v[8:9] op_sel_hi:[1,0]
    v_pk_mul_f32 v[72:73], v[72:73], v[8:9] op_sel_hi:[1,0]
    v_pk_mul_f32 v[74:75], v[74:75], v[8:9] op_sel_hi:[1,0]
    v_pk_mul_f32 v[76:77], v[76:77], v[8:9] op_sel_hi:[1,0]
    v_pk_mul_f32 v[78:79], v[78:79], v[8:9] op_sel_hi:[1,0]
    v_cvt_pk_bf16_f32 v48, v48, v49
    v_cvt_pk_bf16_f32 v49, v50, v51
    v_cvt_pk_bf16_f32 v50, v52, v53
    v_cvt_pk_bf16_f32 v51, v54, v55
    v_cvt_pk_bf16_f32 v52, v56, v57
    v_cvt_pk_bf16_f32 v53, v58, v59
    v_cvt_pk_bf16_f32 v54, v60, v61
    v_cvt_pk_bf16_f32 v55, v62, v63
    v_cvt_pk_bf16_f32 v56, v64, v65
    v_cvt_pk_bf16_f32 v57, v66, v67
    v_cvt_pk_bf16_f32 v58, v68, v69
    v_cvt_pk_bf16_f32 v59, v70, v71
    v_cvt_pk_bf16_f32 v60, v72, v73
    v_cvt_pk_bf16_f32 v61, v74, v75
    v_cvt_pk_bf16_f32 v62, v76, v77
    v_cvt_pk_bf16_f32 v63, v78, v79
    v_permlane16_swap_b32 v48, v50
    v_permlane16_swap_b32 v49, v51
    buffer_store_dwordx4 v[48:51], v5, s[20:23], s34 offen offset:0
    v_permlane16_swap_b32 v52, v54
    v_permlane16_swap_b32 v53, v55
    buffer_store_dwordx4 v[52:55], v5, s[20:23], s34 offen offset:64
    v_permlane16_swap_b32 v56, v58
    v_permlane16_swap_b32 v57, v59
    buffer_store_dwordx4 v[56:59], v5, s[20:23], s34 offen offset:128
    v_permlane16_swap_b32 v60, v62
    v_permlane16_swap_b32 v61, v63
    buffer_store_dwordx4 v[60:63], v5, s[20:23], s34 offen offset:192
    v_mfma_f32_16x16x32_bf16 v[196:199], a[128:131], a[32:35], v[220:223]
    v_exp_f32_e64 v191, v191
    v_mfma_f32_16x16x32_bf16 v[196:199], a[132:135], a[36:39], v[196:199]
    v_cvt_pk_bf16_f32 v207, v190, v191
    v_mfma_f32_16x16x32_bf16 v[196:199], a[136:139], a[40:43], v[196:199]
    v_mfma_f32_16x16x32_bf16 v[196:199], a[140:143], a[44:47], v[196:199]
    v_exp_f32_e64 v192, v192
    v_mfma_f32_16x16x32_bf16 v[80:83], a[144:147], v[204:207], v[80:83]
    v_mfma_f32_16x16x32_bf16 v[84:87], a[148:151], v[204:207], v[84:87]
    v_exp_f32_e64 v193, v193
    v_mfma_f32_16x16x32_bf16 v[88:91], a[152:155], v[204:207], v[88:91]
    v_cvt_pk_bf16_f32 v208, v192, v193
    v_mfma_f32_16x16x32_bf16 v[92:95], a[156:159], v[204:207], v[92:95]
    v_exp_f32_e64 v194, v194
    v_mfma_f32_16x16x32_bf16 v[96:99], a[160:163], v[204:207], v[96:99]
    v_mfma_f32_16x16x32_bf16 v[100:103], a[164:167], v[204:207], v[100:103]
    v_exp_f32_e64 v195, v195
    v_mfma_f32_16x16x32_bf16 v[104:107], a[168:171], v[204:207], v[104:107]
    v_cvt_pk_bf16_f32 v209, v194, v195
    v_mfma_f32_16x16x32_bf16 v[108:111], a[172:175], v[204:207], v[108:111]
    v_exp_f32_e64 v196, v196
    v_mfma_f32_16x16x32_bf16 a[216:219], a[228:231], v[204:207], a[216:219]
    s_nop 0
    v_mfma_f32_16x16x32_bf16 v[176:179], a[80:83], a[48:51], v[224:227]
    v_exp_f32 v197, v197
    v_mfma_f32_16x16x32_bf16 v[176:179], a[84:87], a[52:55], v[176:179]
    v_cvt_pk_bf16_f32 v210, v196, v197
    v_mfma_f32_16x16x32_bf16 v[176:179], a[88:91], a[56:59], v[176:179]
    v_exp_f32_e64 v198, v198
    v_mfma_f32_16x16x32_bf16 v[176:179], a[92:95], a[60:63], v[176:179]
    s_nop 0
    v_mfma_f32_16x16x32_bf16 v[180:183], a[96:99], a[48:51], v[224:227]
    s_nop 0
    v_exp_f32_e64 v199, v199
    v_mfma_f32_16x16x32_bf16 v[180:183], a[100:103], a[52:55], v[180:183]
    v_cvt_pk_bf16_f32 v211, v198, v199
    v_mfma_f32_16x16x32_bf16 v[180:183], a[104:107], a[56:59], v[180:183]
    v_mfma_f32_16x16x32_bf16 v[180:183], a[108:111], a[60:63], v[180:183]
    v_exp_f32_e64 v176, v176
    v_mfma_f32_16x16x32_bf16 v[80:83], a[176:179], v[208:211], v[80:83]
    v_mfma_f32_16x16x32_bf16 v[84:87], a[180:183], v[208:211], v[84:87]
    v_exp_f32_e64 v177, v177
    v_mfma_f32_16x16x32_bf16 v[88:91], a[184:187], v[208:211], v[88:91]
    v_cvt_pk_bf16_f32 v200, v176, v177
    v_mfma_f32_16x16x32_bf16 v[92:95], a[188:191], v[208:211], v[92:95]
    v_exp_f32_e64 v178, v178
    v_mfma_f32_16x16x32_bf16 v[96:99], a[192:195], v[208:211], v[96:99]
    v_mfma_f32_16x16x32_bf16 v[100:103], a[196:199], v[208:211], v[100:103]
    v_exp_f32_e64 v179, v179
    v_mfma_f32_16x16x32_bf16 v[104:107], a[200:203], v[208:211], v[104:107]
    v_cvt_pk_bf16_f32 v201, v178, v179
    v_mfma_f32_16x16x32_bf16 v[108:111], a[204:207], v[208:211], v[108:111]
    v_exp_f32_e64 v180, v180
    v_mfma_f32_16x16x32_bf16 a[216:219], a[228:231], v[208:211], a[216:219]
    s_nop 0
    v_mfma_f32_16x16x32_bf16 v[184:187], a[112:115], a[48:51], v[224:227]
    v_exp_f32 v181, v181
    v_mfma_f32_16x16x32_bf16 v[184:187], a[116:119], a[52:55], v[184:187]
    v_cvt_pk_bf16_f32 v202, v180, v181
    v_mfma_f32_16x16x32_bf16 v[184:187], a[120:123], a[56:59], v[184:187]
    v_exp_f32_e64 v182, v182
    v_mfma_f32_16x16x32_bf16 v[184:187], a[124:127], a[60:63], v[184:187]
    v_accvgpr_read_b32 v10, a216
    s_lshl_b32 s34, s24, 14
    v_add_f32 v1, v1, v10
    v_rcp_f32 v10, v10
    s_add_u32 s34, s34, 8192
    v_pk_mul_f32 v[80:81], v[80:81], v[10:11] op_sel_hi:[1,0]
    v_pk_mul_f32 v[82:83], v[82:83], v[10:11] op_sel_hi:[1,0]
    v_pk_mul_f32 v[84:85], v[84:85], v[10:11] op_sel_hi:[1,0]
    v_pk_mul_f32 v[86:87], v[86:87], v[10:11] op_sel_hi:[1,0]
    v_pk_mul_f32 v[88:89], v[88:89], v[10:11] op_sel_hi:[1,0]
    v_pk_mul_f32 v[90:91], v[90:91], v[10:11] op_sel_hi:[1,0]
    v_pk_mul_f32 v[92:93], v[92:93], v[10:11] op_sel_hi:[1,0]
    v_pk_mul_f32 v[94:95], v[94:95], v[10:11] op_sel_hi:[1,0]
    v_pk_mul_f32 v[96:97], v[96:97], v[10:11] op_sel_hi:[1,0]
    v_pk_mul_f32 v[98:99], v[98:99], v[10:11] op_sel_hi:[1,0]
    v_pk_mul_f32 v[100:101], v[100:101], v[10:11] op_sel_hi:[1,0]
    v_pk_mul_f32 v[102:103], v[102:103], v[10:11] op_sel_hi:[1,0]
    v_pk_mul_f32 v[104:105], v[104:105], v[10:11] op_sel_hi:[1,0]
    v_pk_mul_f32 v[106:107], v[106:107], v[10:11] op_sel_hi:[1,0]
    v_pk_mul_f32 v[108:109], v[108:109], v[10:11] op_sel_hi:[1,0]
    v_pk_mul_f32 v[110:111], v[110:111], v[10:11] op_sel_hi:[1,0]
    v_cvt_pk_bf16_f32 v80, v80, v81
    v_cvt_pk_bf16_f32 v81, v82, v83
    v_cvt_pk_bf16_f32 v82, v84, v85
    v_cvt_pk_bf16_f32 v83, v86, v87
    v_cvt_pk_bf16_f32 v84, v88, v89
    v_cvt_pk_bf16_f32 v85, v90, v91
    v_cvt_pk_bf16_f32 v86, v92, v93
    v_cvt_pk_bf16_f32 v87, v94, v95
    v_cvt_pk_bf16_f32 v88, v96, v97
    v_cvt_pk_bf16_f32 v89, v98, v99
    v_cvt_pk_bf16_f32 v90, v100, v101
    v_cvt_pk_bf16_f32 v91, v102, v103
    v_cvt_pk_bf16_f32 v92, v104, v105
    v_cvt_pk_bf16_f32 v93, v106, v107
    v_cvt_pk_bf16_f32 v94, v108, v109
    v_cvt_pk_bf16_f32 v95, v110, v111
    v_permlane16_swap_b32 v80, v82
    v_permlane16_swap_b32 v81, v83
    buffer_store_dwordx4 v[80:83], v5, s[20:23], s34 offen offset:0
    v_permlane16_swap_b32 v84, v86
    v_permlane16_swap_b32 v85, v87
    buffer_store_dwordx4 v[84:87], v5, s[20:23], s34 offen offset:64
    v_permlane16_swap_b32 v88, v90
    v_permlane16_swap_b32 v89, v91
    buffer_store_dwordx4 v[88:91], v5, s[20:23], s34 offen offset:128
    v_permlane16_swap_b32 v92, v94
    v_permlane16_swap_b32 v93, v95
    buffer_store_dwordx4 v[92:95], v5, s[20:23], s34 offen offset:192
    v_mfma_f32_16x16x32_bf16 v[188:191], a[128:131], a[48:51], v[224:227]
    v_exp_f32_e64 v183, v183
    v_mfma_f32_16x16x32_bf16 v[188:191], a[132:135], a[52:55], v[188:191]
    v_cvt_pk_bf16_f32 v203, v182, v183
    v_mfma_f32_16x16x32_bf16 v[188:191], a[136:139], a[56:59], v[188:191]
    v_mfma_f32_16x16x32_bf16 v[188:191], a[140:143], a[60:63], v[188:191]
    v_exp_f32_e64 v184, v184
    v_mfma_f32_16x16x32_bf16 v[112:115], a[144:147], v[200:203], v[112:115]
    v_mfma_f32_16x16x32_bf16 v[116:119], a[148:151], v[200:203], v[116:119]
    v_exp_f32_e64 v185, v185
    v_mfma_f32_16x16x32_bf16 v[120:123], a[152:155], v[200:203], v[120:123]
    v_cvt_pk_bf16_f32 v204, v184, v185
    v_mfma_f32_16x16x32_bf16 v[124:127], a[156:159], v[200:203], v[124:127]
    v_exp_f32_e64 v186, v186
    v_mfma_f32_16x16x32_bf16 v[128:131], a[160:163], v[200:203], v[128:131]
    v_mfma_f32_16x16x32_bf16 v[132:135], a[164:167], v[200:203], v[132:135]
    v_exp_f32_e64 v187, v187
    v_mfma_f32_16x16x32_bf16 v[136:139], a[168:171], v[200:203], v[136:139]
    v_cvt_pk_bf16_f32 v205, v186, v187
    v_mfma_f32_16x16x32_bf16 v[140:143], a[172:175], v[200:203], v[140:143]
    v_exp_f32_e64 v188, v188
    v_mfma_f32_16x16x32_bf16 a[220:223], a[228:231], v[200:203], a[220:223]
    s_nop 0
    v_mfma_f32_16x16x32_bf16 v[192:195], a[112:115], a[64:67], v[228:231]
    v_exp_f32 v189, v189
    v_mfma_f32_16x16x32_bf16 v[192:195], a[116:119], a[68:71], v[192:195]
    v_cvt_pk_bf16_f32 v206, v188, v189
    v_mfma_f32_16x16x32_bf16 v[192:195], a[120:123], a[72:75], v[192:195]
    v_exp_f32_e64 v190, v190
    v_mfma_f32_16x16x32_bf16 v[192:195], a[124:127], a[76:79], v[192:195]
    s_nop 0
    v_mfma_f32_16x16x32_bf16 v[196:199], a[128:131], a[64:67], v[228:231]
    s_nop 0
    v_exp_f32_e64 v191, v191
    v_mfma_f32_16x16x32_bf16 v[196:199], a[132:135], a[68:71], v[196:199]
    v_cvt_pk_bf16_f32 v207, v190, v191
    v_mfma_f32_16x16x32_bf16 v[196:199], a[136:139], a[72:75], v[196:199]
    v_mfma_f32_16x16x32_bf16 v[196:199], a[140:143], a[76:79], v[196:199]
    v_exp_f32_e64 v192, v192
    v_mfma_f32_16x16x32_bf16 v[112:115], a[176:179], v[204:207], v[112:115]
    v_mfma_f32_16x16x32_bf16 v[116:119], a[180:183], v[204:207], v[116:119]
    v_exp_f32_e64 v193, v193
    v_mfma_f32_16x16x32_bf16 v[120:123], a[184:187], v[204:207], v[120:123]
    v_cvt_pk_bf16_f32 v208, v192, v193
    v_mfma_f32_16x16x32_bf16 v[124:127], a[188:191], v[204:207], v[124:127]
    v_exp_f32_e64 v194, v194
    v_mfma_f32_16x16x32_bf16 v[128:131], a[192:195], v[204:207], v[128:131]
    v_mfma_f32_16x16x32_bf16 v[132:135], a[196:199], v[204:207], v[132:135]
    v_exp_f32_e64 v195, v195
    v_mfma_f32_16x16x32_bf16 v[136:139], a[200:203], v[204:207], v[136:139]
    v_cvt_pk_bf16_f32 v209, v194, v195
    v_mfma_f32_16x16x32_bf16 v[140:143], a[204:207], v[204:207], v[140:143]
    v_exp_f32_e64 v196, v196
    v_mfma_f32_16x16x32_bf16 a[220:223], a[228:231], v[204:207], a[220:223]
    v_exp_f32 v197, v197
    v_exp_f32 v198, v198
    v_exp_f32 v199, v199
    v_lshlrev_b32 v12, 4, v2
    v_cvt_pk_bf16_f32 v210, v196, v197
    v_cvt_pk_bf16_f32 v211, v198, v199
    v_add_u32 v12, 65536, v12
    v_lshlrev_b32 v13, 2, v2
    v_mfma_f32_16x16x32_bf16 a[224:227], a[228:231], v[208:211], a[224:227]
    v_mfma_f32_16x16x32_bf16 v[144:147], a[176:179], v[208:211], v[144:147]
    v_mfma_f32_16x16x32_bf16 v[148:151], a[180:183], v[208:211], v[148:151]
    v_mfma_f32_16x16x32_bf16 v[152:155], a[184:187], v[208:211], v[152:155]
    v_mfma_f32_16x16x32_bf16 v[156:159], a[188:191], v[208:211], v[156:159]
    v_mfma_f32_16x16x32_bf16 v[160:163], a[192:195], v[208:211], v[160:163]
    v_mfma_f32_16x16x32_bf16 v[164:167], a[196:199], v[208:211], v[164:167]
    v_mfma_f32_16x16x32_bf16 v[168:171], a[200:203], v[208:211], v[168:171]
    v_mfma_f32_16x16x32_bf16 v[172:175], a[204:207], v[208:211], v[172:175]
    v_add_u32 v13, 65536, v13
    s_lshl_b32 s34, s24, 12
    v_add_u32 v7, s34, v12
    s_xor_b32 s34, s34, 4096
    v_add_u32 v12, s34, v12
    s_lshl_b32 s34, s24, 9
    v_add_u32 v9, s34, v13
    s_xor_b32 s34, s34, 512
    v_add_u32 v11, s34, v13
    v_accvgpr_read_b32 v14, a220
    s_lshl_b32 s34, s24, 14
    v_add_f32 v1, v1, v14
    v_rcp_f32 v14, v14
    s_add_u32 s34, s34, 12288
    v_accvgpr_read_b32 v192, a224
    s_and_b32 s38, s24, 1
    v_add_f32 v1, v1, v192
    s_cmp_eq_u32 s38, 0
    s_cbranch_scc1 L_even
    ds_write_b128 v7, v[144:147] offset:0
    ds_write_b128 v7, v[148:151] offset:1024
    ds_write_b128 v7, v[152:155] offset:2048
    ds_write_b128 v7, v[156:159] offset:3072
    s_nop 3
    v_mov_b32 v144, v160
    v_mov_b32 v145, v161
    v_mov_b32 v146, v162
    v_mov_b32 v147, v163
    v_mov_b32 v148, v164
    v_mov_b32 v149, v165
    v_mov_b32 v150, v166
    v_mov_b32 v151, v167
    v_mov_b32 v152, v168
    v_mov_b32 v153, v169
    v_mov_b32 v154, v170
    v_mov_b32 v155, v171
    v_mov_b32 v156, v172
    v_mov_b32 v157, v173
    v_mov_b32 v158, v174
    v_mov_b32 v159, v175
    s_branch L_wdone
L_even:
    ds_write_b128 v7, v[160:163] offset:0
    ds_write_b128 v7, v[164:167] offset:1024
    ds_write_b128 v7, v[168:171] offset:2048
    ds_write_b128 v7, v[172:175] offset:3072
L_wdone:
    ds_write_b32 v9, v192 offset:16384
    ds_write_b32 v9, v1 offset:16640
    s_waitcnt lgkmcnt(0)
    s_barrier
    ds_read_b128 v[160:163], v12 offset:0
    ds_read_b128 v[164:167], v12 offset:1024
    ds_read_b128 v[168:171], v12 offset:2048
    ds_read_b128 v[172:175], v12 offset:3072
    ds_read_b32 v193, v11 offset:16384
    ds_read_b32 v16, v13 offset:16640
    ds_read_b32 v17, v13 offset:17152
    ds_read_b32 v18, v13 offset:17664
    ds_read_b32 v19, v13 offset:18176
    v_pk_mul_f32 v[112:113], v[112:113], v[14:15] op_sel_hi:[1,0]
    v_pk_mul_f32 v[114:115], v[114:115], v[14:15] op_sel_hi:[1,0]
    v_pk_mul_f32 v[116:117], v[116:117], v[14:15] op_sel_hi:[1,0]
    v_pk_mul_f32 v[118:119], v[118:119], v[14:15] op_sel_hi:[1,0]
    v_pk_mul_f32 v[120:121], v[120:121], v[14:15] op_sel_hi:[1,0]
    v_pk_mul_f32 v[122:123], v[122:123], v[14:15] op_sel_hi:[1,0]
    v_pk_mul_f32 v[124:125], v[124:125], v[14:15] op_sel_hi:[1,0]
    v_pk_mul_f32 v[126:127], v[126:127], v[14:15] op_sel_hi:[1,0]
    v_pk_mul_f32 v[128:129], v[128:129], v[14:15] op_sel_hi:[1,0]
    v_pk_mul_f32 v[130:131], v[130:131], v[14:15] op_sel_hi:[1,0]
    v_pk_mul_f32 v[132:133], v[132:133], v[14:15] op_sel_hi:[1,0]
    v_pk_mul_f32 v[134:135], v[134:135], v[14:15] op_sel_hi:[1,0]
    v_pk_mul_f32 v[136:137], v[136:137], v[14:15] op_sel_hi:[1,0]
    v_pk_mul_f32 v[138:139], v[138:139], v[14:15] op_sel_hi:[1,0]
    v_pk_mul_f32 v[140:141], v[140:141], v[14:15] op_sel_hi:[1,0]
    v_pk_mul_f32 v[142:143], v[142:143], v[14:15] op_sel_hi:[1,0]
    v_cvt_pk_bf16_f32 v112, v112, v113
    v_cvt_pk_bf16_f32 v113, v114, v115
    v_cvt_pk_bf16_f32 v114, v116, v117
    v_cvt_pk_bf16_f32 v115, v118, v119
    v_cvt_pk_bf16_f32 v116, v120, v121
    v_cvt_pk_bf16_f32 v117, v122, v123
    v_cvt_pk_bf16_f32 v118, v124, v125
    v_cvt_pk_bf16_f32 v119, v126, v127
    v_cvt_pk_bf16_f32 v120, v128, v129
    v_cvt_pk_bf16_f32 v121, v130, v131
    v_cvt_pk_bf16_f32 v122, v132, v133
    v_cvt_pk_bf16_f32 v123, v134, v135
    v_cvt_pk_bf16_f32 v124, v136, v137
    v_cvt_pk_bf16_f32 v125, v138, v139
    v_cvt_pk_bf16_f32 v126, v140, v141
    v_cvt_pk_bf16_f32 v127, v142, v143
    v_permlane16_swap_b32 v112, v114
    v_permlane16_swap_b32 v113, v115
    buffer_store_dwordx4 v[112:115], v5, s[20:23], s34 offen offset:0
    v_permlane16_swap_b32 v116, v118
    v_permlane16_swap_b32 v117, v119
    buffer_store_dwordx4 v[116:119], v5, s[20:23], s34 offen offset:64
    v_permlane16_swap_b32 v120, v122
    v_permlane16_swap_b32 v121, v123
    buffer_store_dwordx4 v[120:123], v5, s[20:23], s34 offen offset:128
    v_permlane16_swap_b32 v124, v126
    v_permlane16_swap_b32 v125, v127
    buffer_store_dwordx4 v[124:127], v5, s[20:23], s34 offen offset:192
    s_waitcnt lgkmcnt(0)
    v_add_f32 v16, v16, v17
    v_add_f32 v18, v18, v19
    v_add_f32 v6, v192, v193
    v_add_f32 v16, v16, v18
    v_mov_b32 v17, 0x53800000
    v_cmp_nlt_f32 vcc, v16, v17
    v_rcp_f32 v6, v6
    s_cmp_lg_u32 s36, 0
    s_cbranch_scc1 L_nofb
    s_cbranch_vccnz L_fallback
L_nofb:
    v_pk_add_f32 v[144:145], v[144:145], v[160:161]
    v_pk_add_f32 v[146:147], v[146:147], v[162:163]
    v_pk_add_f32 v[148:149], v[148:149], v[164:165]
    v_pk_add_f32 v[150:151], v[150:151], v[166:167]
    v_pk_add_f32 v[152:153], v[152:153], v[168:169]
    v_pk_add_f32 v[154:155], v[154:155], v[170:171]
    v_pk_add_f32 v[156:157], v[156:157], v[172:173]
    v_pk_add_f32 v[158:159], v[158:159], v[174:175]
    s_lshr_b32 s34, s24, 1
    s_lshl_b32 s34, s34, 12
    s_lshl_b32 s38, s38, 7
    s_add_u32 s34, s34, s38
    s_add_u32 s34, s34, 65536
    v_pk_mul_f32 v[144:145], v[144:145], v[6:7] op_sel_hi:[1,0]
    v_pk_mul_f32 v[146:147], v[146:147], v[6:7] op_sel_hi:[1,0]
    v_pk_mul_f32 v[148:149], v[148:149], v[6:7] op_sel_hi:[1,0]
    v_pk_mul_f32 v[150:151], v[150:151], v[6:7] op_sel_hi:[1,0]
    v_pk_mul_f32 v[152:153], v[152:153], v[6:7] op_sel_hi:[1,0]
    v_pk_mul_f32 v[154:155], v[154:155], v[6:7] op_sel_hi:[1,0]
    v_pk_mul_f32 v[156:157], v[156:157], v[6:7] op_sel_hi:[1,0]
    v_pk_mul_f32 v[158:159], v[158:159], v[6:7] op_sel_hi:[1,0]
    v_cvt_pk_bf16_f32 v176, v144, v145
    v_cvt_pk_bf16_f32 v177, v146, v147
    v_cvt_pk_bf16_f32 v178, v148, v149
    v_cvt_pk_bf16_f32 v179, v150, v151
    v_cvt_pk_bf16_f32 v180, v152, v153
    v_cvt_pk_bf16_f32 v181, v154, v155
    v_cvt_pk_bf16_f32 v182, v156, v157
    v_cvt_pk_bf16_f32 v183, v158, v159
    s_nop 1
    v_permlane16_swap_b32 v176, v178
    v_permlane16_swap_b32 v177, v179
    buffer_store_dwordx4 v[176:179], v5, s[20:23], s34 offen offset:0
    v_permlane16_swap_b32 v180, v182
    v_permlane16_swap_b32 v181, v183
    buffer_store_dwordx4 v[180:183], v5, s[20:23], s34 offen offset:64
L_end:
    s_endpgm
L_fallback:
    s_mov_b32 s10, 0x80000
    s_mov_b32 s36, 1
    s_mov_b32 s34, 0
    v_lshlrev_b32 v200, 8, v3
    v_lshl_add_u32 v200, v4, 4, v200
    v_mov_b32 v6, 0xff800000
    v_mov_b32 v7, 0xff800000
    v_mov_b32 v8, 0xff800000
    v_mov_b32 v9, 0xff800000
    v_mov_b32 v10, 0xff800000
L_fbloop:
    s_add_u32 s38, s34, 4096
    buffer_load_dwordx4 a[112:115], v200, s[8:11], s34 offen offset:0
    buffer_load_dwordx4 a[116:119], v200, s[8:11], s34 offen offset:64
    buffer_load_dwordx4 a[120:123], v200, s[8:11], s34 offen offset:128
    buffer_load_dwordx4 a[124:127], v200, s[8:11], s34 offen offset:192
    buffer_load_dwordx4 a[128:131], v200, s[8:11], s38 offen offset:0
    buffer_load_dwordx4 a[132:135], v200, s[8:11], s38 offen offset:64
    buffer_load_dwordx4 a[136:139], v200, s[8:11], s38 offen offset:128
    buffer_load_dwordx4 a[140:143], v200, s[8:11], s38 offen offset:192
    s_waitcnt vmcnt(0)
    v_mfma_f32_16x16x32_bf16 v[16:19], a[112:115], a[0:3], 0
    v_mfma_f32_16x16x32_bf16 v[16:19], a[116:119], a[4:7], v[16:19]
    v_mfma_f32_16x16x32_bf16 v[16:19], a[120:123], a[8:11], v[16:19]
    v_mfma_f32_16x16x32_bf16 v[16:19], a[124:127], a[12:15], v[16:19]
    v_mfma_f32_16x16x32_bf16 v[20:23], a[128:131], a[0:3], 0
    v_mfma_f32_16x16x32_bf16 v[20:23], a[132:135], a[4:7], v[20:23]
    v_mfma_f32_16x16x32_bf16 v[20:23], a[136:139], a[8:11], v[20:23]
    v_mfma_f32_16x16x32_bf16 v[20:23], a[140:143], a[12:15], v[20:23]
    v_mfma_f32_16x16x32_bf16 v[24:27], a[112:115], a[16:19], 0
    v_mfma_f32_16x16x32_bf16 v[24:27], a[116:119], a[20:23], v[24:27]
    v_mfma_f32_16x16x32_bf16 v[24:27], a[120:123], a[24:27], v[24:27]
    v_mfma_f32_16x16x32_bf16 v[24:27], a[124:127], a[28:31], v[24:27]
    v_mfma_f32_16x16x32_bf16 v[28:31], a[128:131], a[16:19], 0
    v_mfma_f32_16x16x32_bf16 v[28:31], a[132:135], a[20:23], v[28:31]
    v_mfma_f32_16x16x32_bf16 v[28:31], a[136:139], a[24:27], v[28:31]
    v_mfma_f32_16x16x32_bf16 v[28:31], a[140:143], a[28:31], v[28:31]
    v_mfma_f32_16x16x32_bf16 v[32:35], a[112:115], a[32:35], 0
    v_mfma_f32_16x16x32_bf16 v[32:35], a[116:119], a[36:39], v[32:35]
    v_mfma_f32_16x16x32_bf16 v[32:35], a[120:123], a[40:43], v[32:35]
    v_mfma_f32_16x16x32_bf16 v[32:35], a[124:127], a[44:47], v[32:35]
    v_mfma_f32_16x16x32_bf16 v[36:39], a[128:131], a[32:35], 0
    v_mfma_f32_16x16x32_bf16 v[36:39], a[132:135], a[36:39], v[36:39]
    v_mfma_f32_16x16x32_bf16 v[36:39], a[136:139], a[40:43], v[36:39]
    v_mfma_f32_16x16x32_bf16 v[36:39], a[140:143], a[44:47], v[36:39]
    v_mfma_f32_16x16x32_bf16 v[40:43], a[112:115], a[48:51], 0
    v_mfma_f32_16x16x32_bf16 v[40:43], a[116:119], a[52:55], v[40:43]
    v_mfma_f32_16x16x32_bf16 v[40:43], a[120:123], a[56:59], v[40:43]
    v_mfma_f32_16x16x32_bf16 v[40:43], a[124:127], a[60:63], v[40:43]
    v_mfma_f32_16x16x32_bf16 v[44:47], a[128:131], a[48:51], 0
    v_mfma_f32_16x16x32_bf16 v[44:47], a[132:135], a[52:55], v[44:47]
    v_mfma_f32_16x16x32_bf16 v[44:47], a[136:139], a[56:59], v[44:47]
    v_mfma_f32_16x16x32_bf16 v[44:47], a[140:143], a[60:63], v[44:47]
    v_mfma_f32_16x16x32_bf16 v[48:51], a[112:115], a[64:67], 0
    v_mfma_f32_16x16x32_bf16 v[48:51], a[116:119], a[68:71], v[48:51]
    v_mfma_f32_16x16x32_bf16 v[48:51], a[120:123], a[72:75], v[48:51]
    v_mfma_f32_16x16x32_bf16 v[48:51], a[124:127], a[76:79], v[48:51]
    v_mfma_f32_16x16x32_bf16 v[52:55], a[128:131], a[64:67], 0
    v_mfma_f32_16x16x32_bf16 v[52:55], a[132:135], a[68:71], v[52:55]
    v_mfma_f32_16x16x32_bf16 v[52:55], a[136:139], a[72:75], v[52:55]
    v_mfma_f32_16x16x32_bf16 v[52:55], a[140:143], a[76:79], v[52:55]
    s_nop 7
    v_max3_f32 v6, v6, v16, v17
    v_max3_f32 v6, v6, v18, v19
    v_max3_f32 v6, v6, v20, v21
    v_max3_f32 v6, v6, v22, v23
    v_max3_f32 v7, v7, v24, v25
    v_max3_f32 v7, v7, v26, v27
    v_max3_f32 v7, v7, v28, v29
    v_max3_f32 v7, v7, v30, v31
    v_max3_f32 v8, v8, v32, v33
    v_max3_f32 v8, v8, v34, v35
    v_max3_f32 v8, v8, v36, v37
    v_max3_f32 v8, v8, v38, v39
    v_max3_f32 v9, v9, v40, v41
    v_max3_f32 v9, v9, v42, v43
    v_max3_f32 v9, v9, v44, v45
    v_max3_f32 v9, v9, v46, v47
    v_max3_f32 v10, v10, v48, v49
    v_max3_f32 v10, v10, v50, v51
    v_max3_f32 v10, v10, v52, v53
    v_max3_f32 v10, v10, v54, v55
    s_add_u32 s34, s34, 8192
    s_cmp_lt_u32 s34, 0x80000
    s_cbranch_scc1 L_fbloop
    v_mov_b32 v11, v6
    v_mov_b32 v12, v7
    v_mov_b32 v13, v8
    v_mov_b32 v14, v9
    v_mov_b32 v15, v10
    s_nop 0
    v_permlane16_swap_b32 v6, v11
    v_permlane16_swap_b32 v7, v12
    v_permlane16_swap_b32 v8, v13
    v_permlane16_swap_b32 v9, v14
    v_permlane16_swap_b32 v10, v15
    s_nop 0
    v_max_f32 v6, v6, v11
    v_max_f32 v7, v7, v12
    v_max_f32 v8, v8, v13
    v_max_f32 v9, v9, v14
    v_max_f32 v10, v10, v15
    v_mov_b32 v11, v6
    v_mov_b32 v12, v7
    v_mov_b32 v13, v8
    v_mov_b32 v14, v9
    v_mov_b32 v15, v10
    s_nop 0
    v_permlane32_swap_b32 v6, v11
    v_permlane32_swap_b32 v7, v12
    v_permlane32_swap_b32 v8, v13
    v_permlane32_swap_b32 v9, v14
    v_permlane32_swap_b32 v10, v15
    s_nop 0
    v_max_f32 v6, v6, v11
    v_max_f32 v7, v7, v12
    v_max_f32 v8, v8, v13
    v_max_f32 v9, v9, v14
    v_max_f32 v10, v10, v15
    v_sub_f32 v212, 0, v6
    v_sub_f32 v213, 0, v6
    v_sub_f32 v214, 0, v6
    v_sub_f32 v215, 0, v6
    v_sub_f32 v216, 0, v7
    v_sub_f32 v217, 0, v7
    v_sub_f32 v218, 0, v7
    v_sub_f32 v219, 0, v7
    v_sub_f32 v220, 0, v8
    v_sub_f32 v221, 0, v8
    v_sub_f32 v222, 0, v8
    v_sub_f32 v223, 0, v8
    v_sub_f32 v224, 0, v9
    v_sub_f32 v225, 0, v9
    v_sub_f32 v226, 0, v9
    v_sub_f32 v227, 0, v9
    v_sub_f32 v228, 0, v10
    v_sub_f32 v229, 0, v10
    v_sub_f32 v230, 0, v10
    v_sub_f32 v231, 0, v10
    s_barrier
    s_branch L_restart
L_codeend:
.section .rodata,"a"
.p2align 6
.amdhsa_kernel standalone__mha_softmax__near_ridge_kernel
  .amdhsa_next_free_vgpr 512
  .amdhsa_next_free_sgpr 102
  .amdhsa_accum_offset 256
  .amdhsa_group_segment_fixed_size 0
  .amdhsa_kernarg_size 48
  .amdhsa_user_sgpr_count 2
  .amdhsa_user_sgpr_kernarg_segment_ptr 1
  .amdhsa_system_sgpr_workgroup_id_x 1
.end_amdhsa_kernel
```
